```python
import torch

def _softmax(x, axis=-1):
    return torch.softmax(x, dim=axis)
def _gelu(x):
    return torch.nn.functional.gelu(x, approximate="tanh")
def _silu(x):
    return torch.nn.functional.silu(x)
def _sigmoid(x):
    return torch.sigmoid(x)
def _layernorm(x, axis=-1, eps=1e-5):
    m = x.mean(dim=axis, keepdim=True)
    v = x.var(dim=axis, keepdim=True, unbiased=False)
    return (x - m) / torch.sqrt(v + eps)
def _scatter_add(tgt, idx, src, axis=0):
    return tgt.clone().index_add_(axis, idx, src)
def _segment_sum(src, seg, n):
    out = torch.zeros((n,) + src.shape[1:], dtype=src.dtype)
    return out.index_add_(0, seg, src)
def _pad(x, pw):
    flat = tuple(v for pair in reversed(pw) for v in pair)
    return torch.nn.functional.pad(x, flat)

kernel_name = 'recurrent_scan__sliding_local_dilated__mixer_s_mlp__prompt'

def setup_inputs():

    _w = (lambda a: (lambda t: t.to(torch.bfloat16) if t.is_floating_point() else t)(torch.as_tensor(a)))
    def _A_setup():
        B, S, D = 1, 2048, 640
        return {
            "x": _w((lambda *s: torch.randn(*s, dtype=torch.bfloat16) * 0.05)(B, S, D)),
            "wqkv": _w((lambda *s: torch.randn(*s, dtype=torch.bfloat16) * 0.05)(D, 3 * D)),
            "wo": _w((lambda *s: torch.randn(*s, dtype=torch.bfloat16) * 0.05)(D, D)),
        }
    _A_in = _A_setup()

    def _B_setup():
        B, S, D, F = 1, 2048, 640, 1728
        return {
            "x":  _w((lambda *s: torch.randn(*s, dtype=torch.bfloat16) * 0.05)(B, S, D)),
            "w1": _w((lambda *s: torch.randn(*s, dtype=torch.bfloat16) * 3.2)(D, D) * (D ** -0.5)),
            "w2": _w((lambda *s: torch.randn(*s, dtype=torch.bfloat16) * 3.2)(D, D) * (D ** -0.5)),
            "w3": _w((lambda *s: torch.randn(*s, dtype=torch.bfloat16) * 3.2)(D, F) * (D ** -0.5)),
            "w4": _w((lambda *s: torch.randn(*s, dtype=torch.bfloat16) * 3.2)(F, D) * (F ** -0.5)),
        }
    _B_in = _B_setup()

    return {
        "A_x": _A_in["x"],
        "A_wqkv": _A_in["wqkv"],
        "A_wo": _A_in["wo"],
        "B_x": _B_in["x"],
        "B_w1": _B_in["w1"],
        "B_w2": _B_in["w2"],
        "B_w3": _B_in["w3"],
        "B_w4": _B_in["w4"],
    }

def reference(A_x, A_wqkv, A_wo, B_x, B_w1, B_w2, B_w3, B_w4):
    def _A_ref(x, wqkv, wo):
        B, S, D = x.shape
        H = 32; Dh = D // H
        W, dil = 8, 2
        qkv = (lambda x, *d: x.permute(*d))((x @ wqkv).reshape(B, S, 3, H, Dh), 2, 0, 3, 1, 4)
        q, k, v = qkv[0], qkv[1], qkv[2]
        scale = Dh ** -0.5
        pos = torch.arange(S)
        off = torch.arange(W) * dil
        idx = pos[:, None] - off[None, :]
        mask = idx >= 0
        idx_c = torch.where(mask, idx, 0).reshape(-1)
        kg = k[:, :, idx_c, :].reshape(B, H, S, W, Dh)
        vg = v[:, :, idx_c, :].reshape(B, H, S, W, Dh)
        logits = torch.einsum("bhsd,bhswd->bhsw", q, kg) * scale
        logits = torch.where(mask[None, None, :, :], logits, -1e9)
        attn = _softmax(logits, axis=-1)
        o = torch.einsum("bhsw,bhswd->bhsd", attn, vg)
        return (lambda x, *d: x.permute(*d))(o, 0, 2, 1, 3).reshape(B, S, D) @ wo

    def _B_ref(x, w1, w2, w3, w4):
        B, S, D = x.shape
        h = _gelu(_layernorm(x, axis=-1) @ w1)
        c = D // 4
        g0 = _pad(h[:, :, 0*c:1*c], ((0, 0), (1, 0), (0, 0)))[:, :S, :]
        g1 = _pad(h[:, :, 1*c:2*c], ((0, 0), (0, 1), (0, 0)))[:, 1:, :]
        g2 = _pad(h[:, :, 2*c:3*c], ((0, 0), (2, 0), (0, 0)))[:, :S, :]
        g3 = _pad(h[:, :, 3*c:   ], ((0, 0), (0, 2), (0, 0)))[:, 2:, :]
        hs = torch.concatenate([g0, g1, g2, g3], axis=-1) @ w2
        x1 = x + hs
        h2 = _gelu(_layernorm(x1, axis=-1) @ w3) @ w4
        return x1 + h2

    x = A_x
    xn = _layernorm(x, axis=-1)
    s = _A_ref(xn, A_wqkv, A_wo)
    g = _silu(_B_ref(xn, B_w1, B_w2, B_w3, B_w4))
    return x + s * g
```

```asm
; @launch grid=(256,1,1) block=(512,1,1) lds=154896
.amdgcn_target "amdgcn-amd-amdhsa--gfx950"
.text
.globl recurrent_scan__sliding_local_dilated__mixer_s_mlp__prompt_kernel
.p2align 8
.type recurrent_scan__sliding_local_dilated__mixer_s_mlp__prompt_kernel,@function
recurrent_scan__sliding_local_dilated__mixer_s_mlp__prompt_kernel:
  s_load_dwordx16 s[4:19], s[0:1], 0
  s_load_dwordx4 s[20:23], s[0:1], 64
  s_load_dwordx2 s[24:25], s[0:1], 80
  v_lshrrev_b32 v1, 6, v0
  s_cmp_ge_u32 s2, 256
  s_cbranch_scc1 L_end
  v_readfirstlane_b32 s32, v1
  v_and_b32 v1, 63, v0
  s_and_b32 s35, s2, 1
  s_lshl_b32 s35, s35, 3
  s_bfe_u32 s33, s2, 0x30003
  s_add_u32 s33, s33, s35
  s_bfe_u32 s35, s2, 0x20001
  s_lshl_b32 s35, s35, 2
  s_lshr_b32 s34, s2, 6
  s_add_u32 s34, s34, s35
  s_cmp_lt_u32 s32, 4
  s_cbranch_scc1 L_cons
  s_sub_u32 s58, s32, 4
  s_lshl_b32 s35, s33, 2
  s_add_u32 s35, s35, s58
  s_mul_i32 s59, s35, 40960
  v_lshrrev_b32 v16, 3, v1
  v_mul_u32_u24 v16, 1280, v16
  v_lshrrev_b32 v17, 4, v1
  v_xor_b32 v17, v17, v1
  v_and_b32 v17, 7, v17
  v_lshl_add_u32 v2, v17, 4, v16
  v_xor_b32 v3, 64, v2
  v_add_u32 v3, 9216, v3
  v_add_u32 v4, 18432, v2
  v_add_u32 v5, 18432, v3
  s_movk_i32 s61, 128
  s_lshl_b32 s65, s58, 12
  s_add_u32 s65, s65, 102400
  s_add_u32 s66, s65, 49152
  s_mov_b32 s63, s65
  s_mul_i32 s67, s58, 5120
  s_add_u32 s68, s67, 102400
  s_mov_b32 s64, s67
  s_mov_b32 s42, 2621440
  s_mov_b32 s43, 0x20000
  s_mov_b32 s47, 0x20000
  s_sub_u32 s35, s34, 12
  s_cmp_ge_u32 s34, 12
  s_cselect_b32 s35, s35, s34
  s_mov_b32 s36, 3840
  s_cselect_b32 s36, 1280, s36
  s_mul_i32 s35, s35, 320
  v_add_u32 v16, 0, v1
  v_mul_u32_u24 v17, 3277, v16
  v_lshrrev_b32 v17, 16, v17
  v_mul_u32_u24 v18, 20, v17
  v_sub_u32 v16, v16, v18
  v_lshrrev_b32 v18, 1, v17
  v_and_b32 v18, 2, v18
  v_xor_b32 v16, v16, v18
  v_and_b32 v18, 12, v17
  v_add_u32 v17, v17, v18
  v_lshl_add_u32 v16, v16, 4, s35
  v_mad_u32_u24 v6, v17, s36, v16
  s_sub_u32 s35, s35, 1024
  v_add_u32 v16, 64, v1
  v_mul_u32_u24 v17, 3277, v16
  v_lshrrev_b32 v17, 16, v17
  v_mul_u32_u24 v18, 20, v17
  v_sub_u32 v16, v16, v18
  v_lshrrev_b32 v18, 1, v17
  v_and_b32 v18, 2, v18
  v_xor_b32 v16, v16, v18
  v_and_b32 v18, 12, v17
  v_add_u32 v17, v17, v18
  v_lshl_add_u32 v16, v16, 4, s35
  v_mad_u32_u24 v7, v17, s36, v16
  s_sub_u32 s35, s35, 1024
  v_add_u32 v16, 128, v1
  v_mul_u32_u24 v17, 3277, v16
  v_lshrrev_b32 v17, 16, v17
  v_mul_u32_u24 v18, 20, v17
  v_sub_u32 v16, v16, v18
  v_lshrrev_b32 v18, 1, v17
  v_and_b32 v18, 2, v18
  v_xor_b32 v16, v16, v18
  v_and_b32 v18, 12, v17
  v_add_u32 v17, v17, v18
  v_lshl_add_u32 v16, v16, 4, s35
  v_mad_u32_u24 v8, v17, s36, v16
  s_sub_u32 s35, s35, 1024
  v_add_u32 v16, 192, v1
  v_mul_u32_u24 v17, 3277, v16
  v_lshrrev_b32 v17, 16, v17
  v_mul_u32_u24 v18, 20, v17
  v_sub_u32 v16, v16, v18
  v_lshrrev_b32 v18, 1, v17
  v_and_b32 v18, 2, v18
  v_xor_b32 v16, v16, v18
  v_and_b32 v18, 12, v17
  v_add_u32 v17, v17, v18
  v_lshl_add_u32 v16, v16, 4, s35
  v_mad_u32_u24 v9, v17, s36, v16
  s_add_u32 s35, s35, 3072
  v_add_u32 v16, 256, v1
  v_mul_u32_u24 v17, 3277, v16
  v_lshrrev_b32 v17, 16, v17
  v_mul_u32_u24 v18, 20, v17
  v_sub_u32 v16, v16, v18
  v_lshrrev_b32 v18, 1, v17
  v_and_b32 v18, 2, v18
  v_xor_b32 v16, v16, v18
  v_and_b32 v18, 12, v17
  v_add_u32 v17, v17, v18
  v_lshl_add_u32 v16, v16, 4, s35
  v_mad_u32_u24 v10, v17, s36, v16
  s_lshl_b32 s62, s36, 6
  s_mul_i32 s46, s36, 640
  s_and_b32 s35, s58, 1
  s_lshl_b32 s35, s35, 2
  s_lshr_b32 s60, s58, 1
  s_lshl_b32 s60, s60, 5
  s_add_u32 s60, s60, s35
  s_mul_i32 s60, s60, s36
  s_cmp_ge_u32 s34, 12
  s_waitcnt lgkmcnt(0)
  s_cselect_b32 s44, s12, s6
  s_cselect_b32 s45, s13, s7
  s_mov_b32 s40, s4
  s_mov_b32 s41, s5
  s_branch E_go
E_AW00:
  s_mov_b32 m0, s63
  s_add_u32 s63, s63, 16384
  buffer_load_dwordx4 v2, s[40:43], s59 offen offset:0 lds
  buffer_load_dwordx4 v3, s[40:43], s59 offen offset:1024 lds
  buffer_load_dwordx4 v4, s[40:43], s59 offen offset:2048 lds
  buffer_load_dwordx4 v5, s[40:43], s59 offen offset:3072 lds
  s_cmp_eq_u32 s63, s66
  s_cselect_b32 s63, s65, s63
  s_add_u32 s59, s59, s61
E_W0:
  s_mov_b32 m0, s64
  s_add_u32 s64, s64, 20480
  buffer_load_dwordx4 v6, s[44:47], s60 offen offset:0 lds
  buffer_load_dwordx4 v7, s[44:47], s60 offen offset:1024 lds
  buffer_load_dwordx4 v8, s[44:47], s60 offen offset:2048 lds
  buffer_load_dwordx4 v9, s[44:47], s60 offen offset:3072 lds
  s_add_u32 m0, m0, 0x1000
  s_cmp_eq_u32 s64, s68
  buffer_load_dwordx4 v10, s[44:47], s60 offen lds
  s_cselect_b32 s64, s67, s64
  s_add_u32 s60, s60, s62
  s_setpc_b64 s[56:57]
E_go:
  s_call_b64 s[56:57], E_AW00
  s_call_b64 s[56:57], E_AW00
  s_add_u32 s28, s24, 41943040
  s_addc_u32 s29, s25, 0
  s_mov_b32 s30, 327680
  s_mov_b32 s31, 0x20000
  s_mov_b32 s72, 303104
  buffer_load_dword v22, off, s[28:31], s72 sc1
  v_lshlrev_b32 v20, 4, v1
  v_lshlrev_b32 v21, 2, v1
  s_lshl_b32 s69, s58, 8
  s_add_u32 s69, s69, s2
  s_movk_i32 s36, 1120
  v_add_u32 v16, 0, v1
  v_mul_u32_u24 v17, 6554, v16
  v_lshrrev_b32 v17, 16, v17
  v_lshlrev_b32 v16, 4, v16
  v_mad_u32_u24 v11, v17, s36, v16
  v_add_u32 v16, 64, v1
  v_mul_u32_u24 v17, 6554, v16
  v_lshrrev_b32 v17, 16, v17
  v_lshlrev_b32 v16, 4, v16
  v_mad_u32_u24 v12, v17, s36, v16
  v_add_u32 v16, 128, v1
  v_mul_u32_u24 v17, 6554, v16
  v_lshrrev_b32 v17, 16, v17
  v_lshlrev_b32 v16, 4, v16
  v_mad_u32_u24 v13, v17, s36, v16
  v_add_u32 v16, 192, v1
  v_mul_u32_u24 v17, 6554, v16
  v_lshrrev_b32 v17, 16, v17
  v_lshlrev_b32 v16, 4, v16
  v_mad_u32_u24 v14, v17, s36, v16
  v_add_u32 v16, 256, v1
  v_mul_u32_u24 v17, 6554, v16
  v_lshrrev_b32 v17, 16, v17
  v_lshlrev_b32 v16, 4, v16
  v_mad_u32_u24 v15, v17, s36, v16
  s_mul_i32 s75, s69, 5120
  s_movk_i32 s72, 3277
  s_sub_u32 s35, s69, 160
  s_cmp_ge_u32 s69, 160
  s_cselect_b32 s35, s35, s69
  s_cselect_b32 s52, s8, s14
  s_cselect_b32 s53, s9, s15
  s_sub_u32 s36, s69, 320
  s_cmp_ge_u32 s69, 320
  s_cselect_b32 s35, s36, s35
  s_cselect_b32 s72, 1214, s72
  s_cselect_b32 s73, 54, 20
  s_cselect_b32 s52, s18, s52
  s_cselect_b32 s53, s19, s53
  s_mov_b32 s76, 819200
  s_cselect_b32 s76, 2211840, s76
  s_mov_b32 s55, 0x20000
  s_mul_i32 s72, s72, s35
  s_lshr_b32 s72, s72, 16
  s_mul_i32 s36, s72, s73
  s_sub_u32 s35, s35, s36
  s_mul_i32 s74, s35, 40960
  s_mul_i32 s72, s72, 160
  s_add_u32 s74, s74, s72
  s_cmp_lt_u32 s69, 752
  s_cbranch_scc1 E_nt
  s_mov_b32 s52, s16
  s_mov_b32 s53, s17
  s_sub_u32 s74, s69, 752
  s_lshl_b32 s74, s74, 13
  s_mov_b32 s75, 0x40000000
  v_lshlrev_b32 v11, 7, v1
  v_bfrev_b32 v12, 1
  v_bfrev_b32 v13, 1
  v_bfrev_b32 v14, 1
  v_bfrev_b32 v15, 1
E_nt:
  s_lshl_b32 s77, s69, 2
  s_add_u32 s77, s77, 294912
  s_cmp_lt_u32 s77, 295552
  s_cselect_b32 s54, s76, 0
  buffer_load_dwordx4 v[48:51], v11, s[52:55], s74 offen
  buffer_load_dwordx4 v[52:55], v12, s[52:55], s74 offen
  buffer_load_dwordx4 v[56:59], v13, s[52:55], s74 offen
  buffer_load_dwordx4 v[60:63], v14, s[52:55], s74 offen
  buffer_load_dwordx4 v[64:67], v15, s[52:55], s74 offen
  s_waitcnt vmcnt(15)
  s_barrier
  s_call_b64 s[56:57], E_AW00
  s_waitcnt vmcnt(15)
  s_barrier
  s_call_b64 s[56:57], E_AW00
  s_add_u32 s48, s24, 33554432
  s_addc_u32 s49, s25, 0
  s_mov_b32 s50, 3850240
  s_mov_b32 s51, 0x20000
  s_cmp_lt_u32 s77, 295552
  s_cselect_b32 s50, s50, 0
  s_add_u32 s35, s75, 4096
  s_cmp_ge_u32 s77, 295552
  s_cbranch_scc1 E_r0
  s_waitcnt vmcnt(18)
  buffer_store_dwordx4 v[48:51], v20, s[48:51], s75 offen offset:0 sc1
  buffer_store_dwordx4 v[52:55], v20, s[48:51], s75 offen offset:1024 sc1
  buffer_store_dwordx4 v[56:59], v20, s[48:51], s75 offen offset:2048 sc1
  buffer_store_dwordx4 v[60:63], v20, s[48:51], s75 offen offset:3072 sc1
  buffer_store_dwordx4 v[64:67], v20, s[48:51], s35 offen offset:0 sc1
E_r0:
  s_waitcnt vmcnt(23)
  v_add_u32 v78, 1, v22
  v_mov_b32 v16, 154880
  v_readfirstlane_b32 s37, v78
  ds_write_b32 v16, v78
  v_mov_b64 v[70:71], 0
  ds_write_b64 v16, v[70:71] offset:8
  s_waitcnt vmcnt(9)
  s_barrier
  s_call_b64 s[56:57], E_AW00
  s_waitcnt vmcnt(9)
  s_barrier
  s_call_b64 s[56:57], E_AW00
  s_cmp_lt_u32 s77, 295552
  s_cselect_b32 s35, s77, 0x40000000
  s_waitcnt vmcnt(14)
  v_mov_b32 v16, s37
  s_mov_b64 exec, 1
  buffer_store_dword v16, off, s[28:31], s35 sc1
  s_mov_b64 exec, -1
  s_waitcnt vmcnt(10)
  s_barrier
  s_call_b64 s[56:57], E_AW00
  s_waitcnt vmcnt(10)
  s_barrier
  s_call_b64 s[56:57], E_AW00
  s_waitcnt vmcnt(9)
  s_barrier
  s_call_b64 s[56:57], E_AW00
  s_waitcnt vmcnt(9)
  s_barrier
  s_call_b64 s[56:57], E_AW00
  s_and_b32 s71, s58, 1
  s_lshl_b32 s71, s71, 10
  s_lshl_b32 s35, s33, 11
  s_add_u32 s71, s71, s35
  s_and_b32 s70, s34, 7
  s_mul_i32 s70, s70, 80
  s_add_u32 s70, s70, 294912
  v_min_u32 v17, 76, v21
  buffer_load_dwordx4 v[76:79], v20, s[28:31], s71 offen sc1
  buffer_load_dword v28, v17, s[28:31], s70 offen sc1
  s_cmp_ge_u32 s77, 295552
  s_cselect_b32 s54, s76, 0
  buffer_load_dwordx4 v[48:51], v11, s[52:55], s74 offen
  buffer_load_dwordx4 v[52:55], v12, s[52:55], s74 offen
  buffer_load_dwordx4 v[56:59], v13, s[52:55], s74 offen
  buffer_load_dwordx4 v[60:63], v14, s[52:55], s74 offen
  buffer_load_dwordx4 v[64:67], v15, s[52:55], s74 offen
  s_and_b32 s36, s34, 7
  s_mul_i32 s36, s36, 102400
  s_add_u32 s36, s36, 33554432
  s_add_u32 s44, s24, s36
  s_addc_u32 s45, s25, 0
  s_mov_b32 s46, 102400
  s_mov_b32 s60, s67
  s_movk_i32 s62, 20480
  v_add_u32 v10, 0x1000, v20
  v_mov_b32 v6, v20
  v_mov_b32 v7, v20
  v_mov_b32 v8, v20
  v_mov_b32 v9, v20
  s_waitcnt vmcnt(16)
  s_barrier
  s_waitcnt vmcnt(7)
  s_barrier
  s_waitcnt vmcnt(6)
  v_mov_b32 v16, 154892
  s_mov_b32 s73, 0
L1:
  v_xor_b32 v18, s37, v78
  v_cmp_ne_u32 vcc, 0, v18
  s_add_u32 s73, s73, 1
  s_nop 0
  s_cmp_eq_u64 vcc, 0
  s_cbranch_scc1 L2
  s_cmp_ge_u32 s73, 0x40000
  s_cbranch_scc1 L2
  buffer_load_dwordx4 v[76:79], v20, s[28:31], s71 offen sc1
  s_waitcnt vmcnt(0)
  s_branch L1
L2:
  s_and_b32 s35, s58, 1
  s_lshl_b32 s35, s35, 9
  s_add_u32 s35, s35, 151552
  v_lshl_add_u32 v19, v1, 3, s35
  ds_write_b64 v19, v[76:77] offset:1024
  v_add_f32 v79, 0x3727c5ac, v79
  v_rsq_f32 v79, v79
  v_mov_b32 v70, v76
  s_cmp_ge_u32 s34, 12
  s_cselect_b64 vcc, -1, 0
  v_cndmask_b32 v79, 1.0, v79, vcc
  v_mul_f32 v71, v77, v79
  ds_write_b64 v19, v[70:71]
  s_waitcnt lgkmcnt(0)
  s_barrier
  s_waitcnt vmcnt(5)
  v_mov_b32 v16, 154892
  s_mov_b32 s73, 0
L3:
  v_xor_b32 v18, s37, v28
  v_cmp_ne_u32 vcc, 0, v18
  s_add_u32 s73, s73, 1
  s_nop 0
  s_cmp_eq_u64 vcc, 0
  s_cbranch_scc1 L4
  s_cmp_ge_u32 s73, 0x40000
  s_cbranch_scc1 L4
  s_cmp_lg_u32 s58, 0
  s_cbranch_scc1 L5
  buffer_load_dword v28, v17, s[28:31], s70 offen sc1
  s_waitcnt vmcnt(0)
  s_branch L3
L5:
  ds_read_b32 v18, v16
  s_add_u32 s73, s73, 1
  s_waitcnt lgkmcnt(0)
  v_readfirstlane_b32 s35, v18
  s_nop 1
  s_cmp_ge_u32 s35, 2
  s_cbranch_scc1 L6
  s_cmp_lt_u32 s73, 0x400000
  s_cbranch_scc1 L5
L4:
  s_cmp_lg_u32 s58, 0
  s_cbranch_scc1 L6
  v_mov_b32 v18, 2
  ds_write_b32 v16, v18
L6:
  s_call_b64 s[56:57], E_W1
  s_call_b64 s[56:57], E_W1
  s_call_b64 s[56:57], E_W1
  s_call_b64 s[56:57], E_W1
  s_call_b64 s[56:57], E_W1
  s_add_u32 s48, s24, 33554432
  s_addc_u32 s49, s25, 0
  s_mov_b32 s50, 3850240
  s_mov_b32 s51, 0x20000
  s_cmp_ge_u32 s77, 295552
  s_cselect_b32 s50, s50, 0
  s_add_u32 s35, s75, 4096
  s_waitcnt vmcnt(25)
  buffer_store_dwordx4 v[48:51], v20, s[48:51], s75 offen offset:0 sc1
  buffer_store_dwordx4 v[52:55], v20, s[48:51], s75 offen offset:1024 sc1
  buffer_store_dwordx4 v[56:59], v20, s[48:51], s75 offen offset:2048 sc1
  buffer_store_dwordx4 v[60:63], v20, s[48:51], s75 offen offset:3072 sc1
  buffer_store_dwordx4 v[64:67], v20, s[48:51], s35 offen offset:0 sc1
  s_and_b32 s76, s33, 7
  s_lshl_b32 s76, s76, 2
  s_add_u32 s76, s76, s58
  s_add_u32 s40, s24, 8388608
  s_addc_u32 s41, s25, 0
  s_mov_b32 s42, 2621440
  s_mov_b32 s43, 0x20000
  s_lshl_b32 s59, s33, 3
  s_add_u32 s59, s59, s58
  s_lshr_b32 s36, s34, 3
  s_lshl_b32 s36, s36, 2
  s_add_u32 s59, s59, s36
  s_movk_i32 s61, 4096
  v_mov_b32 v2, v20
  v_mov_b32 v3, v20
  v_mov_b32 v4, v20
  v_mov_b32 v5, v20
  s_lshl_b32 s59, s59, 4
  v_and_b32 v16, 15, v1
  v_add_u32 v16, s59, v16
  v_and_b32 v18, 0x300, v20
  s_movk_i32 s36, 20480
  s_mov_b32 s59, 0
  v_add_u32 v17, -1, v16
  v_bfe_u32 v11, v17, 4, 12
  v_and_b32 v17, 15, v17
  v_lshl_add_u32 v17, v17, 4, v18
  v_mad_u32_u24 v11, v11, s36, v17
  v_add_u32 v17, 1, v16
  v_bfe_u32 v12, v17, 4, 12
  v_and_b32 v17, 15, v17
  v_lshl_add_u32 v17, v17, 4, v18
  v_mad_u32_u24 v12, v12, s36, v17
  v_add_u32 v17, -2, v16
  v_bfe_u32 v13, v17, 4, 12
  v_and_b32 v17, 15, v17
  v_lshl_add_u32 v17, v17, 4, v18
  v_mad_u32_u24 v13, v13, s36, v17
  v_add_u32 v17, 2, v16
  v_bfe_u32 v14, v17, 4, 12
  v_and_b32 v17, 15, v17
  v_lshl_add_u32 v17, v17, 4, v18
  v_mad_u32_u24 v14, v14, s36, v17
  s_lshl_b32 s70, s33, 8
  s_add_u32 s70, s70, 262144
  s_lshr_b32 s35, s34, 3
  s_lshl_b32 s35, s35, 1
  s_add_u32 s35, s35, s33
  s_add_u32 s35, s35, 15
  s_and_b32 s35, s35, 15
  s_lshl_b32 s35, s35, 8
  s_add_u32 s71, s35, 262144
  s_mov_b32 s48, s24
  s_mov_b32 s49, s25
  s_mov_b32 s50, 7864320
  s_mov_b32 s51, 0x20000
  s_add_u32 s35, s58, 1
  s_mul_i32 s36, s35, 43
  s_lshr_b32 s36, s36, 7
  s_mul_i32 s69, s36, 3
  s_sub_u32 s35, s35, s69
  s_lshl_b32 s69, s33, 3
  s_add_u32 s35, s35, s69
  s_lshr_b32 s69, s34, 2
  s_lshl_b32 s69, s69, 1
  s_add_u32 s35, s35, s69
  s_mul_i32 s36, s36, 20
  s_and_b32 s69, s34, 3
  s_mul_i32 s69, s69, 5
  s_add_u32 s36, s36, s69
  s_mul_i32 s69, s35, 60
  s_add_u32 s69, s69, s36
  s_sub_u32 s69, s69, 60
  s_lshl_b32 s69, s69, 10
  s_cmp_eq_u32 s35, 0
  s_cselect_b32 s69, 0x40000000, s69
  s_add_u32 s35, s58, 5
  s_mul_i32 s36, s35, 43
  s_lshr_b32 s36, s36, 7
  s_mul_i32 s72, s36, 3
  s_sub_u32 s35, s35, s72
  s_lshl_b32 s72, s33, 3
  s_add_u32 s35, s35, s72
  s_lshr_b32 s72, s34, 2
  s_lshl_b32 s72, s72, 1
  s_add_u32 s35, s35, s72
  s_mul_i32 s36, s36, 20
  s_and_b32 s72, s34, 3
  s_mul_i32 s72, s72, 5
  s_add_u32 s36, s36, s72
  s_mul_i32 s72, s35, 60
  s_add_u32 s72, s72, s36
  s_sub_u32 s72, s72, 60
  s_lshl_b32 s72, s72, 10
  s_cmp_eq_u32 s35, 0
  s_cselect_b32 s72, 0x40000000, s72
  v_or_b32 v17, 0xc0, v21
  s_lshr_b32 s35, s34, 3
  s_lshl_b32 s35, s35, 2
  s_xor_b32 s35, s35, 4
  v_and_b32 v18, 0xfb, v17
  v_or_b32 v18, s35, v18
  v_add_u32 v18, s71, v18
  v_add_u32 v17, s70, v17
  v_cmp_gt_u32 vcc, 16, v1
  s_nop 1
  v_cndmask_b32 v17, v18, v17, vcc
  s_cmp_eq_u32 s58, 0
  s_mov_b32 s35, 154892
  s_cselect_b32 s35, 154888, s35
  v_mov_b32 v16, s35
  s_mov_b32 s73, 0
L7:
  ds_read_b32 v18, v16
  s_add_u32 s73, s73, 1
  s_waitcnt lgkmcnt(0)
  v_readfirstlane_b32 s35, v18
  s_nop 1
  s_cmp_ge_u32 s35, 4
  s_cbranch_scc1 L8
  s_cmp_lt_u32 s73, 0x400000
  s_cbranch_scc1 L7
L8:
  s_cmp_lg_u32 s58, 0
  s_cbranch_scc1 L9
  s_mov_b32 s73, 0
L10:
  buffer_load_dword v24, v17, s[28:31], 0 offen sc1
  s_waitcnt vmcnt(0)
  v_xor_b32 v24, s37, v24
  v_cmp_ne_u32 vcc, 0, v24
  s_add_u32 s73, s73, 1
  s_nop 0
  s_cmp_eq_u64 vcc, 0
  s_cbranch_scc1 L11
  s_cmp_lt_u32 s73, 0x40000
  s_cbranch_scc1 L10
L11:
  ds_write_b32 v16, v18 offset:4
L9:
  s_mov_b32 m0, s63
  s_add_u32 s63, s63, 16384
  buffer_load_dwordx4 v11, s[40:43], s59 offen offset:0 sc1 lds
  buffer_load_dwordx4 v11, s[40:43], s59 offen offset:1024 sc1 lds
  buffer_load_dwordx4 v11, s[40:43], s59 offen offset:2048 sc1 lds
  buffer_load_dwordx4 v11, s[40:43], s59 offen offset:3072 sc1 lds
  s_cmp_eq_u32 s63, s66
  s_cselect_b32 s63, s65, s63
  s_add_u32 s59, s59, s61
  s_mov_b32 m0, s63
  s_add_u32 s63, s63, 16384
  buffer_load_dwordx4 v11, s[40:43], s59 offen offset:0 sc1 lds
  buffer_load_dwordx4 v12, s[40:43], s59 offen offset:1024 sc1 lds
  buffer_load_dwordx4 v12, s[40:43], s59 offen offset:2048 sc1 lds
  buffer_load_dwordx4 v12, s[40:43], s59 offen offset:3072 sc1 lds
  s_cmp_eq_u32 s63, s66
  s_cselect_b32 s63, s65, s63
  s_add_u32 s59, s59, s61
  s_mov_b32 m0, s63
  s_add_u32 s63, s63, 16384
  buffer_load_dwordx4 v12, s[40:43], s59 offen offset:0 sc1 lds
  buffer_load_dwordx4 v12, s[40:43], s59 offen offset:1024 sc1 lds
  buffer_load_dwordx4 v13, s[40:43], s59 offen offset:2048 sc1 lds
  buffer_load_dwordx4 v13, s[40:43], s59 offen offset:3072 sc1 lds
  s_cmp_eq_u32 s63, s66
  s_cselect_b32 s63, s65, s63
  s_add_u32 s59, s59, s61
  s_waitcnt vmcnt(8)
  s_barrier
  buffer_load_dword v24, v21, s[28:31], s70 offen sc1
  buffer_load_dword v25, v21, s[28:31], s71 offen sc1
  s_cmp_ge_u32 s77, 295552
  s_cselect_b32 s35, s77, 0x40000000
  s_waitcnt vmcnt(14)
  v_mov_b32 v16, s37
  s_mov_b64 exec, 1
  buffer_store_dword v16, off, s[28:31], s35 sc1
  s_mov_b64 exec, -1
  s_waitcnt vmcnt(7)
  s_barrier
  s_mov_b32 m0, s63
  s_add_u32 s63, s63, 16384
  buffer_load_dwordx4 v13, s[40:43], s59 offen offset:0 sc1 lds
  buffer_load_dwordx4 v13, s[40:43], s59 offen offset:1024 sc1 lds
  buffer_load_dwordx4 v13, s[40:43], s59 offen offset:2048 sc1 lds
  buffer_load_dwordx4 v14, s[40:43], s59 offen offset:3072 sc1 lds
  s_cmp_eq_u32 s63, s66
  s_cselect_b32 s63, s65, s63
  s_add_u32 s59, s59, s61
  s_add_u32 s64, s67, 40960
  s_mov_b32 s62, 221184
  s_mul_i32 s60, s58, 55296
  s_mov_b32 s44, s16
  s_mov_b32 s45, s17
  s_mov_b32 s46, 2211840
  s_lshl_b32 s35, s34, 8
  s_movk_i32 s36, 3456
  v_lshrrev_b32 v17, 4, v1
  v_and_b32 v16, 15, v1
  v_lshlrev_b32 v18, 1, v17
  v_xor_b32 v16, v16, v18
  v_lshl_add_u32 v16, v16, 4, s35
  v_xor_b32 v18, 0x80, v16
  v_bfrev_b32 v10, 1
  v_cmp_gt_u32 vcc, s36, v16
  s_nop 1
  v_cndmask_b32 v16, v10, v16, vcc
  v_cmp_gt_u32 vcc, s36, v18
  s_nop 1
  v_cndmask_b32 v18, v10, v18, vcc
  v_mad_u32_u24 v6, v17, s36, v16
  v_mad_u32_u24 v7, v17, s36, v18
  v_add_u32 v7, 12800, v7
  v_add_u32 v8, 25600, v6
  v_add_u32 v9, 25600, v7
  s_waitcnt vmcnt(7)
  s_barrier
  s_mov_b32 m0, s63
  s_add_u32 s63, s63, 16384
  buffer_load_dwordx4 v14, s[40:43], s59 offen offset:0 sc1 lds
  buffer_load_dwordx4 v14, s[40:43], s59 offen offset:1024 sc1 lds
  buffer_load_dwordx4 v14, s[40:43], s59 offen offset:2048 sc1 lds
  buffer_load_dwordx4 v14, s[40:43], s59 offen offset:3072 sc1 lds
  s_cmp_eq_u32 s63, s66
  s_cselect_b32 s63, s65, s63
  s_add_u32 s59, s59, s61
  s_waitcnt vmcnt(9)
  v_mov_b32 v16, 154892
  s_mov_b32 s73, 0
L12:
  v_xor_b32 v18, s37, v24
  v_xor_b32 v25, s37, v25
  v_or_b32 v18, v18, v25
  v_cmp_ne_u32 vcc, 0, v18
  s_add_u32 s73, s73, 1
  s_nop 0
  s_cmp_eq_u64 vcc, 0
  s_cbranch_scc1 L13
  s_cmp_ge_u32 s73, 0x40000
  s_cbranch_scc1 L13
  s_cmp_lg_u32 s58, 0
  s_cbranch_scc1 L14
  buffer_load_dword v24, v21, s[28:31], s70 offen sc1
  buffer_load_dword v25, v21, s[28:31], s71 offen sc1
  s_waitcnt vmcnt(0)
  s_branch L12
L14:
  ds_read_b32 v18, v16
  s_add_u32 s73, s73, 1
  s_waitcnt lgkmcnt(0)
  v_readfirstlane_b32 s35, v18
  s_nop 1
  s_cmp_ge_u32 s35, 5
  s_cbranch_scc1 L15
  s_cmp_lt_u32 s73, 0x400000
  s_cbranch_scc1 L14
L13:
  s_cmp_lg_u32 s58, 0
  s_cbranch_scc1 L15
  v_mov_b32 v18, 5
  ds_write_b32 v16, v18
L15:
  s_add_u32 m0, s67, 0
  s_nop 0
  buffer_load_dwordx4 v20, s[48:51], s69 offen offset:0 sc1 lds
  buffer_load_dwordx4 v20, s[48:51], s69 offen offset:1024 sc1 lds
  buffer_load_dwordx4 v20, s[48:51], s69 offen offset:2048 sc1 lds
  buffer_load_dwordx4 v20, s[48:51], s69 offen offset:3072 sc1 lds
  s_add_u32 m0, m0, 0x1000
  s_add_u32 s69, s69, 0x1000
  buffer_load_dwordx4 v20, s[48:51], s69 offen sc1 lds
  s_waitcnt vmcnt(9)
  s_barrier
  s_add_u32 m0, s67, 20480
  s_nop 0
  buffer_load_dwordx4 v20, s[48:51], s72 offen offset:0 sc1 lds
  buffer_load_dwordx4 v20, s[48:51], s72 offen offset:1024 sc1 lds
  buffer_load_dwordx4 v20, s[48:51], s72 offen offset:2048 sc1 lds
  buffer_load_dwordx4 v20, s[48:51], s72 offen offset:3072 sc1 lds
  s_add_u32 m0, m0, 0x1000
  s_add_u32 s72, s72, 0x1000
  buffer_load_dwordx4 v20, s[48:51], s72 offen sc1 lds
  s_waitcnt vmcnt(10)
  s_barrier
  s_barrier
  s_waitcnt vmcnt(0)
  s_barrier
  s_call_b64 s[56:57], E_W2
  s_call_b64 s[56:57], E_W2
  s_call_b64 s[56:57], E_W2
  s_add_u32 s40, s24, 16777216
  s_addc_u32 s41, s25, 0
  s_mov_b32 s42, 2621440
  s_mov_b32 s43, 0x20000
  s_lshl_b32 s59, s33, 3
  s_add_u32 s59, s59, s58
  s_add_u32 s59, s59, s58
  s_movk_i32 s61, 2048
  s_cmp_ge_u32 s34, 14
  s_cselect_b32 s42, 0, s42
  v_add_u32 v4, 18432, v20
  v_add_u32 v5, 18432, v20
  s_mul_i32 s59, s59, 20480
  s_lshl_b32 s70, s33, 8
  s_add_u32 s70, s70, 266240
  s_add_u32 s48, s24, 12582912
  s_addc_u32 s49, s25, 0
  s_mov_b32 s50, 2621440
  s_mov_b32 s51, 0x20000
  s_lshl_b32 s35, s33, 2
  s_lshr_b32 s36, s34, 2
  s_add_u32 s35, s35, s36
  s_mul_i32 s69, s35, 40960
  s_and_b32 s36, s34, 3
  s_mul_i32 s36, s36, 5120
  s_add_u32 s69, s69, s36
  s_lshl_b32 s35, s58, 10
  v_add_u32 v11, s35, v20
  s_cmp_eq_u32 s58, 0
  s_mov_b32 s36, 19456
  s_cselect_b32 s36, 4096, s36
  v_add_u32 v12, s36, v11
  s_cmp_lt_u32 s58, 2
  s_mov_b32 s36, 0x40000000
  s_cselect_b32 s36, 23552, s36
  v_add_u32 v13, s36, v11
  s_lshl_b32 s35, s58, 8
  s_lshl_b32 s71, s33, 13
  s_add_u32 s71, s71, s35
  s_add_u32 s71, s71, 65536
  s_add_u32 s35, s35, 151552
  v_and_b32 v17, 31, v1
  v_lshl_add_u32 v19, v17, 3, s35
  v_lshrrev_b32 v18, 5, v1
  v_lshlrev_b32 v18, 12, v18
  v_lshl_add_u32 v17, v17, 3, v18
  s_mov_b32 s72, 294912
  buffer_load_dwordx4 v[28:31], v20, s[28:31], s72 offen offset:0 sc1
  buffer_load_dwordx4 v[32:35], v20, s[28:31], s72 offen offset:1024 sc1
  buffer_load_dwordx4 v[36:39], v20, s[28:31], s72 offen offset:2048 sc1
  buffer_load_dwordx4 v[40:43], v20, s[28:31], s72 offen offset:3072 sc1
  s_waitcnt vmcnt(0)
  v_mov_b32 v16, 154892
  s_mov_b32 s73, 0
L16:
  v_xor_b32 v18, s37, v28
  v_xor_b32 v29, s37, v29
  v_or_b32 v18, v18, v29
  v_xor_b32 v30, s37, v30
  v_or_b32 v18, v18, v30
  v_xor_b32 v31, s37, v31
  v_or_b32 v18, v18, v31
  v_xor_b32 v32, s37, v32
  v_or_b32 v18, v18, v32
  v_xor_b32 v33, s37, v33
  v_or_b32 v18, v18, v33
  v_xor_b32 v34, s37, v34
  v_or_b32 v18, v18, v34
  v_xor_b32 v35, s37, v35
  v_or_b32 v18, v18, v35
  v_xor_b32 v36, s37, v36
  v_or_b32 v18, v18, v36
  v_xor_b32 v37, s37, v37
  v_or_b32 v18, v18, v37
  v_xor_b32 v38, s37, v38
  v_or_b32 v18, v18, v38
  v_xor_b32 v39, s37, v39
  v_or_b32 v18, v18, v39
  v_xor_b32 v40, s37, v40
  v_or_b32 v18, v18, v40
  v_xor_b32 v41, s37, v41
  v_or_b32 v18, v18, v41
  v_xor_b32 v42, s37, v42
  v_or_b32 v18, v18, v42
  v_xor_b32 v43, s37, v43
  v_or_b32 v18, v18, v43
  v_cmp_ne_u32 vcc, 0, v18
  s_add_u32 s73, s73, 1
  s_nop 0
  s_cmp_eq_u64 vcc, 0
  s_cbranch_scc1 L17
  s_cmp_ge_u32 s73, 0x40000
  s_cbranch_scc1 L17
  s_cmp_lg_u32 s58, 0
  s_cbranch_scc1 L18
  buffer_load_dwordx4 v[28:31], v20, s[28:31], s72 offen offset:0 sc1
  buffer_load_dwordx4 v[32:35], v20, s[28:31], s72 offen offset:1024 sc1
  buffer_load_dwordx4 v[36:39], v20, s[28:31], s72 offen offset:2048 sc1
  buffer_load_dwordx4 v[40:43], v20, s[28:31], s72 offen offset:3072 sc1
  s_waitcnt vmcnt(0)
  s_branch L16
L18:
  ds_read_b32 v18, v16
  s_add_u32 s73, s73, 1
  s_waitcnt lgkmcnt(0)
  v_readfirstlane_b32 s35, v18
  s_nop 1
  s_cmp_ge_u32 s35, 6
  s_cbranch_scc1 L19
  s_cmp_lt_u32 s73, 0x400000
  s_cbranch_scc1 L18
L17:
  s_cmp_lg_u32 s58, 0
  s_cbranch_scc1 L19
  v_mov_b32 v18, 6
  ds_write_b32 v16, v18
L19:
  s_or_b32 s35, s58, s2
  s_cmp_lg_u32 s35, 0
  s_cbranch_scc1 E_ne
  s_mov_b32 s35, 303104
  v_mov_b32 v16, s37
  s_mov_b64 exec, 1
  buffer_store_dword v16, off, s[28:31], s35 sc1
  s_mov_b64 exec, -1
E_ne:
  s_cmp_eq_u32 s58, 0
  s_mov_b32 s35, 154892
  s_cselect_b32 s35, 154888, s35
  v_mov_b32 v16, s35
  s_mov_b32 s73, 0
L20:
  ds_read_b32 v18, v16
  s_add_u32 s73, s73, 1
  s_waitcnt lgkmcnt(0)
  v_readfirstlane_b32 s35, v18
  s_nop 1
  s_cmp_ge_u32 s35, 8
  s_cbranch_scc1 L21
  s_cmp_lt_u32 s73, 0x400000
  s_cbranch_scc1 L20
L21:
  s_cmp_lg_u32 s58, 0
  s_cbranch_scc1 L22
  s_mov_b32 s73, 0
L23:
  buffer_load_dword v24, v21, s[28:31], s70 offen sc1
  s_waitcnt vmcnt(0)
  v_xor_b32 v24, s37, v24
  v_cmp_ne_u32 vcc, 0, v24
  s_add_u32 s73, s73, 1
  s_nop 0
  s_cmp_eq_u64 vcc, 0
  s_cbranch_scc1 L24
  s_cmp_lt_u32 s73, 0x40000
  s_cbranch_scc1 L23
L24:
  ds_write_b32 v16, v18 offset:4
L22:
  s_call_b64 s[56:57], E_A1
  s_call_b64 s[56:57], E_A1
  s_call_b64 s[56:57], E_A1
  s_waitcnt vmcnt(8)
  s_barrier
  ds_read_b128 v[48:51], v11 offset:0
  ds_read_b128 v[52:55], v11 offset:4096
  ds_read_b128 v[56:59], v11 offset:8192
  buffer_load_dwordx2 v[28:29], v17, s[28:31], s71 offen offset:0 sc1
  buffer_load_dwordx2 v[30:31], v17, s[28:31], s71 offen offset:1024 sc1
  buffer_load_dwordx2 v[32:33], v17, s[28:31], s71 offen offset:2048 sc1
  buffer_load_dwordx2 v[34:35], v17, s[28:31], s71 offen offset:3072 sc1
  s_lshl_b32 s70, s33, 8
  s_add_u32 s70, s70, 270336
  s_lshl_b32 s35, s34, 4
  s_lshl_b32 s36, s58, 2
  s_add_u32 s35, s35, s36
  s_add_u32 s75, s70, s35
  s_waitcnt lgkmcnt(0)
  s_waitcnt vmcnt(8)
  s_barrier
  s_call_b64 s[56:57], E_AW12
  buffer_store_dwordx4 v[48:51], v11, s[48:51], s69 offen sc1
  buffer_store_dwordx4 v[52:55], v12, s[48:51], s69 offen sc1
  buffer_store_dwordx4 v[56:59], v13, s[48:51], s69 offen sc1
  s_waitcnt vmcnt(15)
  s_barrier
  s_call_b64 s[56:57], E_AW12
  s_waitcnt vmcnt(11)
  s_barrier
  s_call_b64 s[56:57], E_AW12
  s_waitcnt vmcnt(16)
  v_mov_b32 v16, s37
  s_mov_b64 exec, 1
  buffer_store_dword v16, off, s[28:31], s75 sc1
  s_mov_b64 exec, -1
  s_waitcnt vmcnt(9)
  s_barrier
  s_call_b64 s[56:57], E_AW12
  s_waitcnt vmcnt(36)
  v_pk_add_f32 v[28:29], v[28:29], v[30:31]
  v_pk_add_f32 v[28:29], v[28:29], v[32:33]
  v_pk_add_f32 v[28:29], v[28:29], v[34:35]
  v_mov_b64 v[30:31], v[28:29]
  s_nop 1
  v_permlane32_swap_b32 v28, v30
  v_permlane32_swap_b32 v29, v31
  v_pk_add_f32 v[28:29], v[28:29], v[30:31]
  v_mov_b32 v72, v29
  v_mul_f32 v28, 0x3acccccd, v28
  v_mul_f32 v72, 0x3acccccd, v72
  v_fma_f32 v72, -v28, v28, v72
  v_max_f32 v72, 0, v72
  v_add_f32 v29, 0x3727c5ac, v72
  v_rsq_f32 v29, v29
  ds_write_b64 v19, v[28:29]
  s_waitcnt lgkmcnt(0)
  s_waitcnt vmcnt(9)
  s_barrier
  s_call_b64 s[56:57], E_AW12
  s_waitcnt vmcnt(8)
  s_barrier
  s_call_b64 s[56:57], E_AW12
  buffer_load_dword v48, v21, s[28:31], s70 offen sc1
  s_waitcnt vmcnt(9)
  s_barrier
  s_call_b64 s[56:57], E_AW12
  s_add_u32 s40, s24, 12582912
  s_addc_u32 s41, s25, 0
  s_mov_b32 s42, 2621440
  s_mov_b32 s43, 0x20000
  s_lshl_b32 s59, s33, 3
  s_add_u32 s59, s59, s58
  s_lshr_b32 s36, s34, 3
  s_lshl_b32 s36, s36, 2
  s_add_u32 s59, s59, s36
  s_movk_i32 s61, 4096
  v_mov_b32 v4, v20
  v_mov_b32 v5, v20
  s_mul_i32 s59, s59, 20480
  s_and_b32 s36, s34, 7
  s_mul_i32 s36, s36, 102400
  s_add_u32 s36, s36, 34373632
  s_add_u32 s44, s24, s36
  s_addc_u32 s45, s25, 0
  s_mov_b32 s46, 102400
  s_mov_b32 s60, s67
  s_movk_i32 s62, 20480
  v_add_u32 v10, 0x1000, v20
  v_mov_b32 v6, v20
  v_mov_b32 v7, v20
  v_mov_b32 v8, v20
  v_mov_b32 v9, v20
  s_waitcnt vmcnt(8)
  v_mov_b32 v16, 154892
  s_mov_b32 s73, 0
L25:
  v_xor_b32 v18, s37, v48
  v_cmp_ne_u32 vcc, 0, v18
  s_add_u32 s73, s73, 1
  s_nop 0
  s_cmp_eq_u64 vcc, 0
  s_cbranch_scc1 L26
  s_cmp_ge_u32 s73, 0x40000
  s_cbranch_scc1 L26
  s_cmp_lg_u32 s58, 0
  s_cbranch_scc1 L27
  buffer_load_dword v48, v21, s[28:31], s70 offen sc1
  s_waitcnt vmcnt(0)
  s_branch L25
L27:
  ds_read_b32 v18, v16
  s_add_u32 s73, s73, 1
  s_waitcnt lgkmcnt(0)
  v_readfirstlane_b32 s35, v18
  s_nop 1
  s_cmp_ge_u32 s35, 9
  s_cbranch_scc1 L28
  s_cmp_lt_u32 s73, 0x400000
  s_cbranch_scc1 L27
L26:
  s_cmp_lg_u32 s58, 0
  s_cbranch_scc1 L28
  v_mov_b32 v18, 9
  ds_write_b32 v16, v18
L28:
  s_waitcnt vmcnt(9)
  s_barrier
  s_call_b64 s[56:57], E_AW11
  s_waitcnt vmcnt(9)
  s_barrier
  s_call_b64 s[56:57], E_AW11
  s_barrier
  s_call_b64 s[56:57], E_AW11
  s_call_b64 s[56:57], E_W1
  s_call_b64 s[56:57], E_W1
  s_and_b32 s36, s34, 7
  s_mul_i32 s36, s36, 276480
  s_add_u32 s36, s36, 35192832
  s_add_u32 s44, s24, s36
  s_addc_u32 s45, s25, 0
  s_mov_b32 s46, 276480
  s_mov_b32 s60, s67
  s_lshl_b32 s70, s33, 8
  s_add_u32 s70, s70, 274432
  s_lshr_b32 s35, s34, 3
  s_lshl_b32 s35, s35, 2
  v_and_b32 v17, 0xfb, v21
  v_or_b32 v17, s35, v17
  s_waitcnt vmcnt(28)
  s_barrier
  s_waitcnt vmcnt(19)
  s_barrier
  s_call_b64 s[56:57], E_AW11
  s_waitcnt vmcnt(19)
  s_barrier
  s_call_b64 s[56:57], E_AW11
  s_waitcnt vmcnt(14)
  s_barrier
  s_call_b64 s[56:57], E_W1
  s_waitcnt vmcnt(10)
  s_barrier
  s_call_b64 s[56:57], E_W1
  s_add_u32 s40, s24, 25165824
  s_addc_u32 s41, s25, 0
  s_mov_b32 s42, 7077888
  s_mov_b32 s43, 0x20000
  s_lshl_b32 s59, s33, 3
  s_add_u32 s59, s59, s58
  s_lshr_b32 s36, s34, 3
  s_lshl_b32 s36, s36, 2
  s_add_u32 s59, s59, s36
  s_movk_i32 s61, 4096
  s_mul_i32 s59, s59, 55296
  s_cmp_eq_u32 s58, 0
  s_mov_b32 s35, 154892
  s_cselect_b32 s35, 154888, s35
  v_mov_b32 v16, s35
  s_mov_b32 s73, 0
L29:
  ds_read_b32 v18, v16
  s_add_u32 s73, s73, 1
  s_waitcnt lgkmcnt(0)
  v_readfirstlane_b32 s35, v18
  s_nop 1
  s_cmp_ge_u32 s35, 12
  s_cbranch_scc1 L30
  s_cmp_lt_u32 s73, 0x400000
  s_cbranch_scc1 L29
L30:
  s_cmp_lg_u32 s58, 0
  s_cbranch_scc1 L31
  s_mov_b32 s73, 0
L32:
  buffer_load_dword v24, v17, s[28:31], s70 offen sc1
  s_waitcnt vmcnt(0)
  v_xor_b32 v24, s37, v24
  v_cmp_ne_u32 vcc, 0, v24
  s_add_u32 s73, s73, 1
  s_nop 0
  s_cmp_eq_u64 vcc, 0
  s_cbranch_scc1 L33
  s_cmp_lt_u32 s73, 0x40000
  s_cbranch_scc1 L32
L33:
  ds_write_b32 v16, v18 offset:4
L31:
  s_call_b64 s[56:57], E_A1
  s_call_b64 s[56:57], E_A1
  s_barrier
  s_call_b64 s[56:57], E_AW11
  s_waitcnt vmcnt(13)
  s_barrier
  s_waitcnt vmcnt(9)
  s_barrier
  s_call_b64 s[56:57], E_AW11
  s_waitcnt vmcnt(14)
  s_barrier
  s_call_b64 s[56:57], E_AW11
  s_waitcnt vmcnt(14)
  s_barrier
  s_call_b64 s[56:57], E_AW11
  s_waitcnt vmcnt(14)
  s_barrier
  s_call_b64 s[56:57], E_AW11
  s_waitcnt vmcnt(14)
  s_barrier
  s_call_b64 s[56:57], E_AW11
  s_waitcnt vmcnt(14)
  s_barrier
  s_call_b64 s[56:57], E_AW11
  s_waitcnt vmcnt(14)
  s_barrier
  s_call_b64 s[56:57], E_AW11
  s_waitcnt vmcnt(14)
  s_barrier
  s_call_b64 s[56:57], E_AW11
  s_waitcnt vmcnt(14)
  s_barrier
  s_call_b64 s[56:57], E_AW11
  s_waitcnt vmcnt(14)
  s_barrier
  s_call_b64 s[56:57], E_A1
  s_waitcnt vmcnt(9)
  s_barrier
  v_bfrev_b32 v4, 1
  v_bfrev_b32 v5, 1
  s_call_b64 s[56:57], E_A1
  s_waitcnt vmcnt(4)
  s_barrier
  s_waitcnt vmcnt(0)
  s_barrier
  s_barrier
  s_barrier
  s_endpgm
E_AW11:
  s_mov_b32 m0, s63
  s_add_u32 s63, s63, 16384
  buffer_load_dwordx4 v2, s[40:43], s59 offen offset:0 sc1 lds
  buffer_load_dwordx4 v3, s[40:43], s59 offen offset:1024 sc1 lds
  buffer_load_dwordx4 v4, s[40:43], s59 offen offset:2048 sc1 lds
  buffer_load_dwordx4 v5, s[40:43], s59 offen offset:3072 sc1 lds
  s_cmp_eq_u32 s63, s66
  s_cselect_b32 s63, s65, s63
  s_add_u32 s59, s59, s61
E_W1:
  s_mov_b32 m0, s64
  s_add_u32 s64, s64, 20480
  buffer_load_dwordx4 v6, s[44:47], s60 offen offset:0 sc1 lds
  buffer_load_dwordx4 v7, s[44:47], s60 offen offset:1024 sc1 lds
  buffer_load_dwordx4 v8, s[44:47], s60 offen offset:2048 sc1 lds
  buffer_load_dwordx4 v9, s[44:47], s60 offen offset:3072 sc1 lds
  s_add_u32 m0, m0, 0x1000
  s_cmp_eq_u32 s64, s68
  buffer_load_dwordx4 v10, s[44:47], s60 offen sc1 lds
  s_cselect_b32 s64, s67, s64
  s_add_u32 s60, s60, s62
  s_setpc_b64 s[56:57]
E_AW12:
  s_mov_b32 m0, s63
  s_add_u32 s63, s63, 16384
  buffer_load_dwordx4 v2, s[40:43], s59 offen offset:0 sc1 lds
  buffer_load_dwordx4 v3, s[40:43], s59 offen offset:1024 sc1 lds
  buffer_load_dwordx4 v4, s[40:43], s59 offen offset:2048 sc1 lds
  buffer_load_dwordx4 v5, s[40:43], s59 offen offset:3072 sc1 lds
  s_cmp_eq_u32 s63, s66
  s_cselect_b32 s63, s65, s63
  s_add_u32 s59, s59, s61
E_W2:
  s_mov_b32 m0, s64
  s_add_u32 s64, s64, 20480
  buffer_load_dwordx4 v6, s[44:47], s60 offen offset:0 lds
  buffer_load_dwordx4 v7, s[44:47], s60 offen offset:1024 lds
  buffer_load_dwordx4 v8, s[44:47], s60 offen offset:2048 lds
  buffer_load_dwordx4 v9, s[44:47], s60 offen offset:3072 lds
  s_cmp_eq_u32 s64, s68
  s_cselect_b32 s64, s67, s64
  s_add_u32 s60, s60, s62
  s_setpc_b64 s[56:57]
E_A1:
  s_mov_b32 m0, s63
  s_add_u32 s63, s63, 16384
  buffer_load_dwordx4 v2, s[40:43], s59 offen offset:0 sc1 lds
  buffer_load_dwordx4 v3, s[40:43], s59 offen offset:1024 sc1 lds
  buffer_load_dwordx4 v4, s[40:43], s59 offen offset:2048 sc1 lds
  buffer_load_dwordx4 v5, s[40:43], s59 offen offset:3072 sc1 lds
  s_cmp_eq_u32 s63, s66
  s_cselect_b32 s63, s65, s63
  s_add_u32 s59, s59, s61
  s_setpc_b64 s[56:57]
L_cons:
  s_mov_b32 s37, -1
  s_waitcnt lgkmcnt(0)
  s_add_u32 s28, s24, 41943040
  s_addc_u32 s29, s25, 0
  s_mov_b32 s30, 327680
  s_mov_b32 s31, 0x20000
  s_mov_b32 s35, 303104
  buffer_load_dword v12, off, s[28:31], s35 sc1
  s_lshl_b32 s35, s33, 4
  s_add_u32 s35, s35, s34
  s_lshl_b32 s35, s35, 1
  s_and_b32 s36, s32, 1
  s_add_u32 s35, s35, s36
  s_lshl_b32 s35, s35, 2
  v_lshrrev_b32 v10, 4, v1
  v_add_u32 v10, s35, v10
  v_lshlrev_b32 v126, 4, v10
  v_mul_u32_u24 v10, 1280, v10
  v_and_b32 v11, 15, v1
  v_lshl_add_u32 v10, v11, 4, v10
  s_cmp_lt_u32 s32, 2
  s_cbranch_scc1 C_nx
  global_load_dwordx4 v[100:103], v10, s[4:5] offset:0
  global_load_dwordx4 v[104:107], v10, s[4:5] offset:256
  global_load_dwordx4 v[108:111], v10, s[4:5] offset:512
  global_load_dwordx4 v[112:115], v10, s[4:5] offset:768
  global_load_dwordx4 v[116:119], v10, s[4:5] offset:1024
C_nx:
  s_lshl_b32 s35, s33, 2
  s_and_b32 s36, s34, 3
  s_add_u32 s35, s35, s36
  s_mul_i32 s35, s35, 40960
  v_lshl_add_u32 v10, v0, 7, s35
  v_lshl_add_u32 v11, v1, 7, s35
  v_add_u32 v11, 0x8000, v11
  global_load_dword v4, v10, s[4:5]
  global_load_dword v4, v11, s[4:5]
  s_sub_u32 s35, s34, 12
  s_cmp_ge_u32 s34, 12
  s_cselect_b32 s35, s35, s34
  s_mov_b32 s36, 3840
  s_cselect_b32 s36, 1280, s36
  s_cselect_b32 s40, s12, s6
  s_cselect_b32 s41, s13, s7
  s_mul_i32 s35, s35, 320
  s_and_b32 s48, s33, 7
  v_min_u32 v10, 239, v0
  v_mul_u32_u24 v11, 21846, v10
  v_lshrrev_b32 v11, 16, v11
  v_mul_u32_u24 v8, 3, v11
  v_sub_u32 v10, v10, v8
  v_lshl_add_u32 v10, v10, 7, s35
  v_lshl_add_u32 v11, v11, 3, s48
  v_mad_u32_u24 v10, v11, s36, v10
  global_load_dword v4, v10, s[40:41]
  s_getpc_b64 s[60:61]
L_pc:
  s_sub_u32 s60, s60, L_pc-recurrent_scan__sliding_local_dilated__mixer_s_mlp__prompt_kernel
  s_subb_u32 s61, s61, 0
  s_and_b32 s35, s33, 7
  s_lshl_b32 s35, s35, 2
  s_add_u32 s35, s35, s32
  s_mul_i32 s35, s35, 640
  v_min_u32 v2, 4, v1
  v_lshl_add_u32 v2, v2, 7, s35
  v_min_u32 v2, L_end-recurrent_scan__sliding_local_dilated__mixer_s_mlp__prompt_kernel, v2
  global_load_dword v4, v2, s[60:61]
  s_and_b32 s44, s32, 1
  s_lshr_b32 s45, s32, 1
  v_and_b32 v8, 15, v1
  v_lshrrev_b32 v9, 4, v1
  s_mov_b32 s60, 0xbdd2d3e8
  s_mov_b32 s61, 0xc0135761
  s_mov_b32 s46, 102400
  s_mov_b32 s47, 0
  s_lshl_b32 s58, s33, 8
  s_lshl_b32 s35, s34, 4
  s_add_u32 s58, s58, s35
  s_lshl_b32 s35, s32, 2
  s_add_u32 s58, s58, s35
  s_add_u32 s58, s58, 262144
  v_mov_b32 v44, 0x3f803f80
  v_mov_b32 v45, 0x3f803f80
  v_mov_b32 v46, 0x3f803f80
  v_mov_b32 v47, 0x3f803f80
  s_lshl_b32 s35, s44, 2
  v_add_u32 v10, s35, v9
  v_lshrrev_b32 v11, 1, v8
  v_xor_b32 v10, v10, v11
  v_lshlrev_b32 v10, 4, v10
  v_lshl_add_u32 v10, v8, 7, v10
  s_lshl_b32 s35, s44, 13
  v_add_u32 v48, s35, v10
  v_xor_b32 v49, 64, v48
  v_lshrrev_b32 v10, 2, v1
  v_mul_u32_u24 v10, 320, v10
  v_and_b32 v11, 3, v1
  v_lshl_add_u32 v10, v11, 3, v10
  s_mul_i32 s35, s44, 10240
  v_add_u32 v10, s35, v10
  v_and_b32 v11, 1, v9
  s_lshl_b32 s35, s45, 2
  v_xor_b32 v50, s35, v11
  v_xor_b32 v51, 1, v50
  s_add_u32 s36, s45, 8
  v_xor_b32 v52, s36, v11
  s_mul_i32 s35, s44, -20480
  s_add_u32 s35, s35, 10240
  v_lshl_add_u32 v50, v50, 5, v10
  v_add_u32 v53, s35, v50
  v_lshl_add_u32 v51, v51, 5, v10
  v_add_u32 v54, s35, v51
  v_lshl_add_u32 v52, v52, 5, v10
  v_add_u32 v55, s35, v52
  s_cmp_ge_u32 s34, 12
  s_mov_b32 s52, 61440
  s_cselect_b32 s52, 20480, s52
  s_cselect_b32 s35, 12, 0
  s_sub_u32 s51, s34, s35
  s_mul_i32 s51, s51, 5120
  s_lshl_b32 s50, s45, 11
  s_add_u32 s50, s50, s51
  s_lshl_b32 s35, s45, 9
  s_add_u32 s51, s51, s35
  s_add_u32 s51, s51, 4096
  s_lshl_b32 s35, s33, 3
  s_lshl_b32 s36, s44, 2
  s_add_u32 s35, s35, s36
  s_mul_i32 s53, s52, s35
  v_mov_b64 v[140:141], 0
  v_mov_b64 v[142:143], 0
  v_mov_b64 v[144:145], 0
  v_mov_b64 v[146:147], 0
  v_mov_b64 v[148:149], 0
  v_mov_b64 v[150:151], 0
  v_mov_b64 v[152:153], 0
  v_mov_b64 v[154:155], 0
  v_mov_b64 v[156:157], 0
  v_mov_b64 v[158:159], 0
  v_mov_b64 v[160:161], 0
  v_mov_b64 v[162:163], 0
  v_mov_b64 v[164:165], 0
  v_mov_b64 v[166:167], 0
  v_mov_b64 v[168:169], 0
  v_mov_b64 v[170:171], 0
  v_mov_b64 v[172:173], 0
  v_mov_b64 v[174:175], 0
  v_mov_b64 v[176:177], 0
  v_mov_b64 v[178:179], 0
  v_mov_b64 v[180:181], 0
  v_mov_b64 v[182:183], 0
  v_mov_b64 v[184:185], 0
  v_mov_b64 v[186:187], 0
  v_mov_b64 v[188:189], 0
  v_mov_b64 v[190:191], 0
  v_mov_b64 v[192:193], 0
  v_mov_b64 v[194:195], 0
  v_mov_b64 v[196:197], 0
  v_mov_b64 v[198:199], 0
  v_mov_b64 v[200:201], 0
  v_mov_b64 v[202:203], 0
  v_mov_b64 v[204:205], 0
  v_mov_b64 v[206:207], 0
  v_mov_b64 v[208:209], 0
  v_mov_b64 v[210:211], 0
  v_mov_b64 v[212:213], 0
  v_mov_b64 v[214:215], 0
  v_mov_b64 v[216:217], 0
  v_mov_b64 v[218:219], 0
  v_mov_b64 v[220:221], 0
  v_mov_b64 v[222:223], 0
  v_mov_b64 v[224:225], 0
  v_mov_b64 v[226:227], 0
  v_mov_b64 v[228:229], 0
  v_mov_b64 v[230:231], 0
  v_mov_b64 v[232:233], 0
  v_mov_b64 v[234:235], 0
  v_mov_b64 v[236:237], 0
  v_mov_b64 v[238:239], 0
  s_and_b32 s54, s34, 1
  s_lshl_b32 s55, s54, 2
  s_xor_b32 s55, s55, 4
  s_lshl_b32 s49, s44, 1
  s_add_u32 s49, s49, s45
  s_lshl_b32 s35, s49, 12
  s_lshl_b32 s36, s45, 11
  s_add_u32 s35, s35, s36
  v_lshl_add_u32 v38, v1, 4, s35
  v_xor_b32 v39, 0x1000, v38
  v_lshrrev_b32 v10, 2, v1
  v_and_b32 v11, 8, v10
  v_add_u32 v10, v10, v11
  v_mul_u32_u24 v10, 160, v10
  v_and_b32 v11, 3, v1
  v_lshl_add_u32 v10, v11, 3, v10
  s_mul_i32 s35, s45, 10240
  v_add_u32 v10, s35, v10
  s_and_b32 s36, s34, 7
  s_mul_i32 s35, s36, 5
  s_add_u32 s56, s35, s54
  s_lshl_b32 s56, s56, 9
  s_add_u32 s35, s35, s55
  s_lshr_b32 s57, s35, 1
  s_lshl_b32 s57, s57, 10
  s_lshl_b32 s35, s54, 9
  s_add_u32 s57, s57, s35
  s_lshl_b32 s54, s54, 5
  s_lshl_b32 s55, s55, 5
  v_add_u32 v40, s54, v10
  v_add_u32 v41, s55, v10
  s_lshr_b32 s35, s34, 3
  s_lshl_b32 s35, s35, 2
  s_add_u32 s49, s49, s35
  s_lshl_b32 s35, s33, 3
  s_add_u32 s49, s49, s35
  s_lshl_b32 s35, s49, 4
  v_add_u32 v10, s35, v8
  v_mul_u32_u24 v42, 1280, v10
  v_lshl_add_u32 v42, v9, 3, v42
  s_mul_i32 s36, s36, 160
  v_add_u32 v42, s36, v42
  v_mov_b32 v43, v10
  s_mov_b32 s49, 0
  v_add_u32 v56, s46, v48
  v_add_u32 v58, s47, v50
  v_add_u32 v59, s47, v51
  v_add_u32 v60, s47, v52
  v_add_u32 v57, s46, v49
  v_add_u32 v62, s47, v53
  v_add_u32 v63, s47, v54
  v_add_u32 v64, s47, v55
  s_waitcnt vmcnt(4)
  v_add_u32 v12, 1, v12
  v_mov_b32 v130, v12
  v_mov_b64 v[122:123], 0
  s_cmp_lt_u32 s32, 2
  s_cbranch_scc1 C_ns
  v_mov_b64 v[124:125], 0
  v_lshlrev_b32 v120, 16, v100
  v_and_b32 v121, 0xffff0000, v100
  v_pk_add_f32 v[122:123], v[122:123], v[120:121]
  v_pk_fma_f32 v[124:125], v[120:121], v[120:121], v[124:125]
  v_lshlrev_b32 v120, 16, v101
  v_and_b32 v121, 0xffff0000, v101
  v_pk_add_f32 v[122:123], v[122:123], v[120:121]
  v_pk_fma_f32 v[124:125], v[120:121], v[120:121], v[124:125]
  v_lshlrev_b32 v120, 16, v102
  v_and_b32 v121, 0xffff0000, v102
  v_pk_add_f32 v[122:123], v[122:123], v[120:121]
  v_pk_fma_f32 v[124:125], v[120:121], v[120:121], v[124:125]
  v_lshlrev_b32 v120, 16, v103
  v_and_b32 v121, 0xffff0000, v103
  v_pk_add_f32 v[122:123], v[122:123], v[120:121]
  v_pk_fma_f32 v[124:125], v[120:121], v[120:121], v[124:125]
  v_lshlrev_b32 v120, 16, v104
  v_and_b32 v121, 0xffff0000, v104
  v_pk_add_f32 v[122:123], v[122:123], v[120:121]
  v_pk_fma_f32 v[124:125], v[120:121], v[120:121], v[124:125]
  v_lshlrev_b32 v120, 16, v105
  v_and_b32 v121, 0xffff0000, v105
  v_pk_add_f32 v[122:123], v[122:123], v[120:121]
  v_pk_fma_f32 v[124:125], v[120:121], v[120:121], v[124:125]
  v_lshlrev_b32 v120, 16, v106
  v_and_b32 v121, 0xffff0000, v106
  v_pk_add_f32 v[122:123], v[122:123], v[120:121]
  v_pk_fma_f32 v[124:125], v[120:121], v[120:121], v[124:125]
  v_lshlrev_b32 v120, 16, v107
  v_and_b32 v121, 0xffff0000, v107
  v_pk_add_f32 v[122:123], v[122:123], v[120:121]
  v_pk_fma_f32 v[124:125], v[120:121], v[120:121], v[124:125]
  v_lshlrev_b32 v120, 16, v108
  v_and_b32 v121, 0xffff0000, v108
  v_pk_add_f32 v[122:123], v[122:123], v[120:121]
  v_pk_fma_f32 v[124:125], v[120:121], v[120:121], v[124:125]
  v_lshlrev_b32 v120, 16, v109
  v_and_b32 v121, 0xffff0000, v109
  v_pk_add_f32 v[122:123], v[122:123], v[120:121]
  v_pk_fma_f32 v[124:125], v[120:121], v[120:121], v[124:125]
  v_lshlrev_b32 v120, 16, v110
  v_and_b32 v121, 0xffff0000, v110
  v_pk_add_f32 v[122:123], v[122:123], v[120:121]
  v_pk_fma_f32 v[124:125], v[120:121], v[120:121], v[124:125]
  v_lshlrev_b32 v120, 16, v111
  v_and_b32 v121, 0xffff0000, v111
  v_pk_add_f32 v[122:123], v[122:123], v[120:121]
  v_pk_fma_f32 v[124:125], v[120:121], v[120:121], v[124:125]
  v_lshlrev_b32 v120, 16, v112
  v_and_b32 v121, 0xffff0000, v112
  v_pk_add_f32 v[122:123], v[122:123], v[120:121]
  v_pk_fma_f32 v[124:125], v[120:121], v[120:121], v[124:125]
  v_lshlrev_b32 v120, 16, v113
  v_and_b32 v121, 0xffff0000, v113
  v_pk_add_f32 v[122:123], v[122:123], v[120:121]
  v_pk_fma_f32 v[124:125], v[120:121], v[120:121], v[124:125]
  v_lshlrev_b32 v120, 16, v114
  v_and_b32 v121, 0xffff0000, v114
  v_pk_add_f32 v[122:123], v[122:123], v[120:121]
  v_pk_fma_f32 v[124:125], v[120:121], v[120:121], v[124:125]
  v_lshlrev_b32 v120, 16, v115
  v_and_b32 v121, 0xffff0000, v115
  v_pk_add_f32 v[122:123], v[122:123], v[120:121]
  v_pk_fma_f32 v[124:125], v[120:121], v[120:121], v[124:125]
  v_lshlrev_b32 v120, 16, v116
  v_and_b32 v121, 0xffff0000, v116
  v_pk_add_f32 v[122:123], v[122:123], v[120:121]
  v_pk_fma_f32 v[124:125], v[120:121], v[120:121], v[124:125]
  v_lshlrev_b32 v120, 16, v117
  v_and_b32 v121, 0xffff0000, v117
  v_pk_add_f32 v[122:123], v[122:123], v[120:121]
  v_pk_fma_f32 v[124:125], v[120:121], v[120:121], v[124:125]
  v_lshlrev_b32 v120, 16, v118
  v_and_b32 v121, 0xffff0000, v118
  v_pk_add_f32 v[122:123], v[122:123], v[120:121]
  v_pk_fma_f32 v[124:125], v[120:121], v[120:121], v[124:125]
  v_lshlrev_b32 v120, 16, v119
  v_and_b32 v121, 0xffff0000, v119
  v_pk_add_f32 v[122:123], v[122:123], v[120:121]
  v_pk_fma_f32 v[124:125], v[120:121], v[120:121], v[124:125]
  v_add_f32 v122, v122, v123
  v_add_f32 v124, v124, v125
  s_nop 0
  v_add_f32_dpp v122, v122, v122 row_ror:8 row_mask:0xf bank_mask:0xf
  v_add_f32_dpp v124, v124, v124 row_ror:8 row_mask:0xf bank_mask:0xf
  s_nop 0
  v_add_f32_dpp v122, v122, v122 row_ror:4 row_mask:0xf bank_mask:0xf
  v_add_f32_dpp v124, v124, v124 row_ror:4 row_mask:0xf bank_mask:0xf
  s_nop 0
  v_add_f32_dpp v122, v122, v122 row_ror:2 row_mask:0xf bank_mask:0xf
  v_add_f32_dpp v124, v124, v124 row_ror:2 row_mask:0xf bank_mask:0xf
  s_nop 0
  v_add_f32_dpp v122, v122, v122 row_ror:1 row_mask:0xf bank_mask:0xf
  v_add_f32_dpp v124, v124, v124 row_ror:1 row_mask:0xf bank_mask:0xf
  v_mul_f32 v122, 0x3acccccd, v122
  v_mul_f32 v124, 0x3acccccd, v124
  v_fma_f32 v124, -v122, v122, v124
  v_max_f32 v124, 0, v124
  v_add_f32 v129, 0x3727c5ac, v124
  v_rsq_f32 v129, v129
  v_mov_b32 v128, v122
  v_mul_f32 v131, v129, v129
  v_mul_f32 v131, v131, v124
  s_mov_b32 exec_lo, 0x00010001
  s_mov_b32 exec_hi, 0x00010001
  buffer_store_dwordx4 v[128:131], v126, s[28:31], 0 offen sc1
  s_mov_b64 exec, -1
C_ns:
  s_mov_b32 s48, 0
  s_barrier
  ds_read_b128 v[68:71], v56 offset:0
  ds_read_b64_tr_b16 v[100:101], v58 offset:0
  ds_read_b64_tr_b16 v[102:103], v58 offset:5120
  ds_read_b128 v[72:75], v56 offset:2048
  ds_read_b128 v[76:79], v56 offset:4096
  ds_read_b128 v[80:83], v56 offset:6144
  ds_read_b64_tr_b16 v[104:105], v59 offset:0
  ds_read_b64_tr_b16 v[106:107], v59 offset:5120
  ds_read_b64_tr_b16 v[108:109], v58 offset:64
  ds_read_b64_tr_b16 v[110:111], v58 offset:5184
  ds_read_b64_tr_b16 v[112:113], v59 offset:64
  ds_read_b64_tr_b16 v[114:115], v59 offset:5184
  ds_read_b64_tr_b16 v[116:117], v60 offset:0
  ds_read_b64_tr_b16 v[118:119], v60 offset:5120
  s_branch C1_l
C1_cs:
  s_mul_i32 s35, s32, 320
  s_add_u32 s35, s35, 153600
  v_lshlrev_b32 v10, 4, v9
  v_add_u32 v11, s35, v10
  s_mov_b32 exec_lo, 0x00010001
  s_mov_b32 exec_hi, 0x00010001
  ds_write_b128 v11, v[220:223] offset:0
  ds_write_b128 v11, v[224:227] offset:64
  ds_write_b128 v11, v[228:231] offset:128
  ds_write_b128 v11, v[232:235] offset:192
  ds_write_b128 v11, v[236:239] offset:256
  s_mov_b64 exec, -1
  s_xor_b32 s35, s32, 1
  s_mul_i32 s35, s35, 320
  s_add_u32 s35, s35, 153600
  v_add_u32 v11, s35, v10
  s_lshl_b32 s35, s44, 9
  s_add_u32 s35, s35, 151552
  v_lshl_add_u32 v10, v8, 3, s35
  s_branch C1_b
C1_l:
  s_add_u32 s46, s46, 16384
  s_cmp_eq_u32 s46, 151552
  s_cselect_b32 s46, 102400, s46
  s_add_u32 s47, s47, 20480
  s_cmp_eq_u32 s47, 102400
  s_cselect_b32 s47, 0, s47
  s_waitcnt lgkmcnt(0)
  v_mfma_f32_16x16x32_bf16 v[140:143], v[100:103], v[68:71], v[140:143]
  ds_read_b128 v[84:87], v57 offset:0
  v_mfma_f32_16x16x32_bf16 v[160:163], v[100:103], v[72:75], v[160:163]
  ds_read_b64_tr_b16 v[120:121], v62 offset:0
  v_mfma_f32_16x16x32_bf16 v[180:183], v[100:103], v[76:79], v[180:183]
  ds_read_b64_tr_b16 v[122:123], v62 offset:5120
  v_mfma_f32_16x16x32_bf16 v[200:203], v[100:103], v[80:83], v[200:203]
  ds_read_b128 v[88:91], v57 offset:2048
  v_mfma_f32_16x16x32_bf16 v[220:223], v[100:103], v[44:47], v[220:223]
  ds_read_b128 v[92:95], v57 offset:4096
  v_mfma_f32_16x16x32_bf16 v[144:147], v[104:107], v[68:71], v[144:147]
  ds_read_b128 v[96:99], v57 offset:6144
  v_mfma_f32_16x16x32_bf16 v[164:167], v[104:107], v[72:75], v[164:167]
  ds_read_b64_tr_b16 v[124:125], v63 offset:0
  v_mfma_f32_16x16x32_bf16 v[184:187], v[104:107], v[76:79], v[184:187]
  ds_read_b64_tr_b16 v[126:127], v63 offset:5120
  v_mfma_f32_16x16x32_bf16 v[204:207], v[104:107], v[80:83], v[204:207]
  ds_read_b64_tr_b16 v[128:129], v62 offset:64
  v_mfma_f32_16x16x32_bf16 v[224:227], v[104:107], v[44:47], v[224:227]
  ds_read_b64_tr_b16 v[130:131], v62 offset:5184
  v_mfma_f32_16x16x32_bf16 v[148:151], v[108:111], v[68:71], v[148:151]
  ds_read_b64_tr_b16 v[132:133], v63 offset:64
  v_mfma_f32_16x16x32_bf16 v[168:171], v[108:111], v[72:75], v[168:171]
  ds_read_b64_tr_b16 v[134:135], v63 offset:5184
  v_mfma_f32_16x16x32_bf16 v[188:191], v[108:111], v[76:79], v[188:191]
  ds_read_b64_tr_b16 v[136:137], v64 offset:0
  v_mfma_f32_16x16x32_bf16 v[208:211], v[108:111], v[80:83], v[208:211]
  ds_read_b64_tr_b16 v[138:139], v64 offset:5120
  v_mfma_f32_16x16x32_bf16 v[228:231], v[108:111], v[44:47], v[228:231]
  v_add_u32 v56, s46, v48
  v_mfma_f32_16x16x32_bf16 v[152:155], v[112:115], v[68:71], v[152:155]
  v_add_u32 v58, s47, v50
  v_mfma_f32_16x16x32_bf16 v[172:175], v[112:115], v[72:75], v[172:175]
  v_add_u32 v59, s47, v51
  v_mfma_f32_16x16x32_bf16 v[192:195], v[112:115], v[76:79], v[192:195]
  v_add_u32 v60, s47, v52
  v_mfma_f32_16x16x32_bf16 v[212:215], v[112:115], v[80:83], v[212:215]
  v_mfma_f32_16x16x32_bf16 v[232:235], v[112:115], v[44:47], v[232:235]
  v_mfma_f32_16x16x32_bf16 v[156:159], v[116:119], v[68:71], v[156:159]
  v_mfma_f32_16x16x32_bf16 v[176:179], v[116:119], v[72:75], v[176:179]
  v_mfma_f32_16x16x32_bf16 v[196:199], v[116:119], v[76:79], v[196:199]
  v_mfma_f32_16x16x32_bf16 v[216:219], v[116:119], v[80:83], v[216:219]
  v_mfma_f32_16x16x32_bf16 v[236:239], v[116:119], v[44:47], v[236:239]
  s_cmp_eq_u32 s48, 9
  s_cbranch_scc1 C1_cs
C1_b:
  s_waitcnt lgkmcnt(0)
  s_barrier
  v_mfma_f32_16x16x32_bf16 v[140:143], v[120:123], v[84:87], v[140:143]
  ds_read_b128 v[68:71], v56 offset:0
  v_mfma_f32_16x16x32_bf16 v[160:163], v[120:123], v[88:91], v[160:163]
  ds_read_b64_tr_b16 v[100:101], v58 offset:0
  v_mfma_f32_16x16x32_bf16 v[180:183], v[120:123], v[92:95], v[180:183]
  ds_read_b64_tr_b16 v[102:103], v58 offset:5120
  v_mfma_f32_16x16x32_bf16 v[200:203], v[120:123], v[96:99], v[200:203]
  ds_read_b128 v[72:75], v56 offset:2048
  v_mfma_f32_16x16x32_bf16 v[144:147], v[124:127], v[84:87], v[144:147]
  ds_read_b128 v[76:79], v56 offset:4096
  v_mfma_f32_16x16x32_bf16 v[164:167], v[124:127], v[88:91], v[164:167]
  ds_read_b128 v[80:83], v56 offset:6144
  v_mfma_f32_16x16x32_bf16 v[184:187], v[124:127], v[92:95], v[184:187]
  ds_read_b64_tr_b16 v[104:105], v59 offset:0
  v_mfma_f32_16x16x32_bf16 v[204:207], v[124:127], v[96:99], v[204:207]
  ds_read_b64_tr_b16 v[106:107], v59 offset:5120
  v_mfma_f32_16x16x32_bf16 v[148:151], v[128:131], v[84:87], v[148:151]
  ds_read_b64_tr_b16 v[108:109], v58 offset:64
  v_mfma_f32_16x16x32_bf16 v[168:171], v[128:131], v[88:91], v[168:171]
  ds_read_b64_tr_b16 v[110:111], v58 offset:5184
  v_mfma_f32_16x16x32_bf16 v[188:191], v[128:131], v[92:95], v[188:191]
  ds_read_b64_tr_b16 v[112:113], v59 offset:64
  v_mfma_f32_16x16x32_bf16 v[208:211], v[128:131], v[96:99], v[208:211]
  ds_read_b64_tr_b16 v[114:115], v59 offset:5184
  v_mfma_f32_16x16x32_bf16 v[152:155], v[132:135], v[84:87], v[152:155]
  ds_read_b64_tr_b16 v[116:117], v60 offset:0
  v_mfma_f32_16x16x32_bf16 v[172:175], v[132:135], v[88:91], v[172:175]
  ds_read_b64_tr_b16 v[118:119], v60 offset:5120
  v_mfma_f32_16x16x32_bf16 v[192:195], v[132:135], v[92:95], v[192:195]
  v_add_u32 v57, s46, v49
  v_mfma_f32_16x16x32_bf16 v[212:215], v[132:135], v[96:99], v[212:215]
  v_add_u32 v62, s47, v53
  v_mfma_f32_16x16x32_bf16 v[156:159], v[136:139], v[84:87], v[156:159]
  v_add_u32 v63, s47, v54
  v_add_u32 v64, s47, v55
  v_mfma_f32_16x16x32_bf16 v[176:179], v[136:139], v[88:91], v[176:179]
  s_add_u32 s48, s48, 1
  s_cmp_lt_u32 s48, 10
  v_mfma_f32_16x16x32_bf16 v[196:199], v[136:139], v[92:95], v[196:199]
  v_mfma_f32_16x16x32_bf16 v[216:219], v[136:139], v[96:99], v[216:219]
  s_cbranch_scc1 C1_l
  s_cmp_ge_u32 s34, 12
  s_cselect_b32 s35, 8388608, 0
  s_add_u32 s40, s24, s35
  s_addc_u32 s41, s25, 0
  s_lshl_b32 s42, s52, 7
  s_mov_b32 s43, 0x20000
  ds_read_b128 v[100:103], v11 offset:0
  ds_read_b128 v[104:107], v11 offset:64
  ds_read_b128 v[108:111], v11 offset:128
  ds_read_b128 v[112:115], v11 offset:192
  ds_read_b128 v[116:119], v11 offset:256
  ds_read_b64 v[68:69], v10 offset:0
  ds_read_b64 v[70:71], v10 offset:128
  ds_read_b64 v[72:73], v10 offset:256
  ds_read_b64 v[74:75], v10 offset:384
  v_lshl_add_u32 v58, v1, 4, s53
  v_add_u32 v59, s52, v58
  v_add_u32 v60, s52, v59
  v_add_u32 v61, s52, v60
  s_waitcnt lgkmcnt(0)
  v_pk_add_f32 v[220:221], v[220:221], v[100:101]
  v_pk_add_f32 v[222:223], v[222:223], v[102:103]
  v_pk_add_f32 v[224:225], v[224:225], v[104:105]
  v_pk_add_f32 v[226:227], v[226:227], v[106:107]
  v_pk_add_f32 v[228:229], v[228:229], v[108:109]
  v_pk_add_f32 v[230:231], v[230:231], v[110:111]
  v_pk_add_f32 v[232:233], v[232:233], v[112:113]
  v_pk_add_f32 v[234:235], v[234:235], v[114:115]
  v_pk_add_f32 v[236:237], v[236:237], v[116:117]
  v_pk_add_f32 v[238:239], v[238:239], v[118:119]
  v_pk_fma_f32 v[140:141], v[220:221], v[68:69], v[140:141] op_sel_hi:[1,0,1] neg_lo:[0,1,0] neg_hi:[0,1,0]
  v_pk_fma_f32 v[142:143], v[222:223], v[68:69], v[142:143] op_sel_hi:[1,0,1] neg_lo:[0,1,0] neg_hi:[0,1,0]
  v_pk_fma_f32 v[144:145], v[224:225], v[68:69], v[144:145] op_sel_hi:[1,0,1] neg_lo:[0,1,0] neg_hi:[0,1,0]
  v_pk_fma_f32 v[146:147], v[226:227], v[68:69], v[146:147] op_sel_hi:[1,0,1] neg_lo:[0,1,0] neg_hi:[0,1,0]
  v_pk_fma_f32 v[148:149], v[228:229], v[68:69], v[148:149] op_sel_hi:[1,0,1] neg_lo:[0,1,0] neg_hi:[0,1,0]
  v_pk_fma_f32 v[150:151], v[230:231], v[68:69], v[150:151] op_sel_hi:[1,0,1] neg_lo:[0,1,0] neg_hi:[0,1,0]
  v_pk_fma_f32 v[152:153], v[232:233], v[68:69], v[152:153] op_sel_hi:[1,0,1] neg_lo:[0,1,0] neg_hi:[0,1,0]
  v_pk_fma_f32 v[154:155], v[234:235], v[68:69], v[154:155] op_sel_hi:[1,0,1] neg_lo:[0,1,0] neg_hi:[0,1,0]
  v_pk_fma_f32 v[156:157], v[236:237], v[68:69], v[156:157] op_sel_hi:[1,0,1] neg_lo:[0,1,0] neg_hi:[0,1,0]
  v_pk_fma_f32 v[158:159], v[238:239], v[68:69], v[158:159] op_sel_hi:[1,0,1] neg_lo:[0,1,0] neg_hi:[0,1,0]
  s_cmp_lt_u32 s34, 12
  s_cbranch_scc1 C1_ng0
  v_mul_f32 v2, v69, v69
  v_mul_f32 v3, s61, v69
  v_mul_f32 v2, v2, v69
  v_rcp_f32 v69, v69
  v_mul_f32 v2, s60, v2
  v_pk_mul_f32 v[120:121], v[140:141], v[140:141]
  v_pk_mul_f32 v[122:123], v[142:143], v[142:143]
  v_pk_mul_f32 v[124:125], v[144:145], v[144:145]
  v_pk_mul_f32 v[126:127], v[146:147], v[146:147]
  v_pk_mul_f32 v[128:129], v[148:149], v[148:149]
  v_pk_mul_f32 v[130:131], v[150:151], v[150:151]
  v_pk_mul_f32 v[132:133], v[152:153], v[152:153]
  v_pk_mul_f32 v[134:135], v[154:155], v[154:155]
  v_pk_mul_f32 v[136:137], v[156:157], v[156:157]
  v_pk_mul_f32 v[138:139], v[158:159], v[158:159]
  v_pk_fma_f32 v[120:121], v[120:121], v[2:3], v[2:3] op_sel:[0,0,1] op_sel_hi:[1,0,1]
  v_pk_fma_f32 v[122:123], v[122:123], v[2:3], v[2:3] op_sel:[0,0,1] op_sel_hi:[1,0,1]
  v_pk_fma_f32 v[124:125], v[124:125], v[2:3], v[2:3] op_sel:[0,0,1] op_sel_hi:[1,0,1]
  v_pk_fma_f32 v[126:127], v[126:127], v[2:3], v[2:3] op_sel:[0,0,1] op_sel_hi:[1,0,1]
  v_pk_fma_f32 v[128:129], v[128:129], v[2:3], v[2:3] op_sel:[0,0,1] op_sel_hi:[1,0,1]
  v_pk_fma_f32 v[130:131], v[130:131], v[2:3], v[2:3] op_sel:[0,0,1] op_sel_hi:[1,0,1]
  v_pk_fma_f32 v[132:133], v[132:133], v[2:3], v[2:3] op_sel:[0,0,1] op_sel_hi:[1,0,1]
  v_pk_fma_f32 v[134:135], v[134:135], v[2:3], v[2:3] op_sel:[0,0,1] op_sel_hi:[1,0,1]
  v_pk_fma_f32 v[136:137], v[136:137], v[2:3], v[2:3] op_sel:[0,0,1] op_sel_hi:[1,0,1]
  v_pk_fma_f32 v[138:139], v[138:139], v[2:3], v[2:3] op_sel:[0,0,1] op_sel_hi:[1,0,1]
  v_pk_mul_f32 v[120:121], v[120:121], v[140:141]
  v_pk_mul_f32 v[122:123], v[122:123], v[142:143]
  v_pk_mul_f32 v[124:125], v[124:125], v[144:145]
  v_pk_mul_f32 v[126:127], v[126:127], v[146:147]
  v_pk_mul_f32 v[128:129], v[128:129], v[148:149]
  v_pk_mul_f32 v[130:131], v[130:131], v[150:151]
  v_pk_mul_f32 v[132:133], v[132:133], v[152:153]
  v_pk_mul_f32 v[134:135], v[134:135], v[154:155]
  v_pk_mul_f32 v[136:137], v[136:137], v[156:157]
  v_pk_mul_f32 v[138:139], v[138:139], v[158:159]
  v_exp_f32 v120, v120
  v_exp_f32 v121, v121
  v_exp_f32 v122, v122
  v_exp_f32 v123, v123
  v_exp_f32 v124, v124
  v_exp_f32 v125, v125
  v_exp_f32 v126, v126
  v_exp_f32 v127, v127
  v_exp_f32 v128, v128
  v_exp_f32 v129, v129
  v_exp_f32 v130, v130
  v_exp_f32 v131, v131
  v_exp_f32 v132, v132
  v_exp_f32 v133, v133
  v_exp_f32 v134, v134
  v_exp_f32 v135, v135
  v_exp_f32 v136, v136
  v_exp_f32 v137, v137
  v_exp_f32 v138, v138
  v_exp_f32 v139, v139
  v_pk_fma_f32 v[120:121], v[120:121], v[68:69], v[68:69] op_sel:[0,1,1] op_sel_hi:[1,1,1]
  v_pk_fma_f32 v[122:123], v[122:123], v[68:69], v[68:69] op_sel:[0,1,1] op_sel_hi:[1,1,1]
  v_pk_fma_f32 v[124:125], v[124:125], v[68:69], v[68:69] op_sel:[0,1,1] op_sel_hi:[1,1,1]
  v_pk_fma_f32 v[126:127], v[126:127], v[68:69], v[68:69] op_sel:[0,1,1] op_sel_hi:[1,1,1]
  v_pk_fma_f32 v[128:129], v[128:129], v[68:69], v[68:69] op_sel:[0,1,1] op_sel_hi:[1,1,1]
  v_pk_fma_f32 v[130:131], v[130:131], v[68:69], v[68:69] op_sel:[0,1,1] op_sel_hi:[1,1,1]
  v_pk_fma_f32 v[132:133], v[132:133], v[68:69], v[68:69] op_sel:[0,1,1] op_sel_hi:[1,1,1]
  v_pk_fma_f32 v[134:135], v[134:135], v[68:69], v[68:69] op_sel:[0,1,1] op_sel_hi:[1,1,1]
  v_pk_fma_f32 v[136:137], v[136:137], v[68:69], v[68:69] op_sel:[0,1,1] op_sel_hi:[1,1,1]
  v_pk_fma_f32 v[138:139], v[138:139], v[68:69], v[68:69] op_sel:[0,1,1] op_sel_hi:[1,1,1]
  v_rcp_f32 v120, v120
  v_rcp_f32 v121, v121
  v_rcp_f32 v122, v122
  v_rcp_f32 v123, v123
  v_rcp_f32 v124, v124
  v_rcp_f32 v125, v125
  v_rcp_f32 v126, v126
  v_rcp_f32 v127, v127
  v_rcp_f32 v128, v128
  v_rcp_f32 v129, v129
  v_rcp_f32 v130, v130
  v_rcp_f32 v131, v131
  v_rcp_f32 v132, v132
  v_rcp_f32 v133, v133
  v_rcp_f32 v134, v134
  v_rcp_f32 v135, v135
  v_rcp_f32 v136, v136
  v_rcp_f32 v137, v137
  v_rcp_f32 v138, v138
  v_rcp_f32 v139, v139
  v_pk_mul_f32 v[140:141], v[140:141], v[120:121]
  v_pk_mul_f32 v[142:143], v[142:143], v[122:123]
  v_pk_mul_f32 v[144:145], v[144:145], v[124:125]
  v_pk_mul_f32 v[146:147], v[146:147], v[126:127]
  v_pk_mul_f32 v[148:149], v[148:149], v[128:129]
  v_pk_mul_f32 v[150:151], v[150:151], v[130:131]
  v_pk_mul_f32 v[152:153], v[152:153], v[132:133]
  v_pk_mul_f32 v[154:155], v[154:155], v[134:135]
  v_pk_mul_f32 v[156:157], v[156:157], v[136:137]
  v_pk_mul_f32 v[158:159], v[158:159], v[138:139]
  s_branch C1_pk0
C1_ng0:
  v_pk_mul_f32 v[140:141], v[140:141], v[68:69] op_sel:[0,1] op_sel_hi:[1,1]
  v_pk_mul_f32 v[142:143], v[142:143], v[68:69] op_sel:[0,1] op_sel_hi:[1,1]
  v_pk_mul_f32 v[144:145], v[144:145], v[68:69] op_sel:[0,1] op_sel_hi:[1,1]
  v_pk_mul_f32 v[146:147], v[146:147], v[68:69] op_sel:[0,1] op_sel_hi:[1,1]
  v_pk_mul_f32 v[148:149], v[148:149], v[68:69] op_sel:[0,1] op_sel_hi:[1,1]
  v_pk_mul_f32 v[150:151], v[150:151], v[68:69] op_sel:[0,1] op_sel_hi:[1,1]
  v_pk_mul_f32 v[152:153], v[152:153], v[68:69] op_sel:[0,1] op_sel_hi:[1,1]
  v_pk_mul_f32 v[154:155], v[154:155], v[68:69] op_sel:[0,1] op_sel_hi:[1,1]
  v_pk_mul_f32 v[156:157], v[156:157], v[68:69] op_sel:[0,1] op_sel_hi:[1,1]
  v_pk_mul_f32 v[158:159], v[158:159], v[68:69] op_sel:[0,1] op_sel_hi:[1,1]
C1_pk0:
  v_cvt_pk_bf16_f32 v84, v140, v141
  v_cvt_pk_bf16_f32 v85, v142, v143
  v_cvt_pk_bf16_f32 v86, v144, v145
  v_cvt_pk_bf16_f32 v87, v146, v147
  v_cvt_pk_bf16_f32 v88, v148, v149
  v_cvt_pk_bf16_f32 v89, v150, v151
  v_cvt_pk_bf16_f32 v90, v152, v153
  v_cvt_pk_bf16_f32 v91, v154, v155
  v_cvt_pk_bf16_f32 v92, v156, v157
  v_cvt_pk_bf16_f32 v93, v158, v159
  v_mov_b64 v[94:95], v[92:93]
  v_permlane32_swap_b32 v84, v86
  v_permlane32_swap_b32 v85, v87
  v_permlane32_swap_b32 v88, v90
  v_permlane32_swap_b32 v89, v91
  v_permlane32_swap_b32 v92, v94
  v_permlane32_swap_b32 v93, v95
  buffer_store_dwordx4 v[84:87], v58, s[40:43], s50 offen sc1
  buffer_store_dwordx4 v[88:91], v58, s[40:43], s50 offen offset:1024 sc1
  s_mov_b32 exec_hi, 0
  buffer_store_dwordx4 v[92:95], v58, s[40:43], s51 offen sc1
  s_mov_b32 exec_hi, -1
  v_pk_fma_f32 v[160:161], v[220:221], v[70:71], v[160:161] op_sel_hi:[1,0,1] neg_lo:[0,1,0] neg_hi:[0,1,0]
  v_pk_fma_f32 v[162:163], v[222:223], v[70:71], v[162:163] op_sel_hi:[1,0,1] neg_lo:[0,1,0] neg_hi:[0,1,0]
  v_pk_fma_f32 v[164:165], v[224:225], v[70:71], v[164:165] op_sel_hi:[1,0,1] neg_lo:[0,1,0] neg_hi:[0,1,0]
  v_pk_fma_f32 v[166:167], v[226:227], v[70:71], v[166:167] op_sel_hi:[1,0,1] neg_lo:[0,1,0] neg_hi:[0,1,0]
  v_pk_fma_f32 v[168:169], v[228:229], v[70:71], v[168:169] op_sel_hi:[1,0,1] neg_lo:[0,1,0] neg_hi:[0,1,0]
  v_pk_fma_f32 v[170:171], v[230:231], v[70:71], v[170:171] op_sel_hi:[1,0,1] neg_lo:[0,1,0] neg_hi:[0,1,0]
  v_pk_fma_f32 v[172:173], v[232:233], v[70:71], v[172:173] op_sel_hi:[1,0,1] neg_lo:[0,1,0] neg_hi:[0,1,0]
  v_pk_fma_f32 v[174:175], v[234:235], v[70:71], v[174:175] op_sel_hi:[1,0,1] neg_lo:[0,1,0] neg_hi:[0,1,0]
  v_pk_fma_f32 v[176:177], v[236:237], v[70:71], v[176:177] op_sel_hi:[1,0,1] neg_lo:[0,1,0] neg_hi:[0,1,0]
  v_pk_fma_f32 v[178:179], v[238:239], v[70:71], v[178:179] op_sel_hi:[1,0,1] neg_lo:[0,1,0] neg_hi:[0,1,0]
  s_cmp_lt_u32 s34, 12
  s_cbranch_scc1 C1_ng1
  v_mul_f32 v2, v71, v71
  v_mul_f32 v3, s61, v71
  v_mul_f32 v2, v2, v71
  v_rcp_f32 v71, v71
  v_mul_f32 v2, s60, v2
  v_pk_mul_f32 v[120:121], v[160:161], v[160:161]
  v_pk_mul_f32 v[122:123], v[162:163], v[162:163]
  v_pk_mul_f32 v[124:125], v[164:165], v[164:165]
  v_pk_mul_f32 v[126:127], v[166:167], v[166:167]
  v_pk_mul_f32 v[128:129], v[168:169], v[168:169]
  v_pk_mul_f32 v[130:131], v[170:171], v[170:171]
  v_pk_mul_f32 v[132:133], v[172:173], v[172:173]
  v_pk_mul_f32 v[134:135], v[174:175], v[174:175]
  v_pk_mul_f32 v[136:137], v[176:177], v[176:177]
  v_pk_mul_f32 v[138:139], v[178:179], v[178:179]
  v_pk_fma_f32 v[120:121], v[120:121], v[2:3], v[2:3] op_sel:[0,0,1] op_sel_hi:[1,0,1]
  v_pk_fma_f32 v[122:123], v[122:123], v[2:3], v[2:3] op_sel:[0,0,1] op_sel_hi:[1,0,1]
  v_pk_fma_f32 v[124:125], v[124:125], v[2:3], v[2:3] op_sel:[0,0,1] op_sel_hi:[1,0,1]
  v_pk_fma_f32 v[126:127], v[126:127], v[2:3], v[2:3] op_sel:[0,0,1] op_sel_hi:[1,0,1]
  v_pk_fma_f32 v[128:129], v[128:129], v[2:3], v[2:3] op_sel:[0,0,1] op_sel_hi:[1,0,1]
  v_pk_fma_f32 v[130:131], v[130:131], v[2:3], v[2:3] op_sel:[0,0,1] op_sel_hi:[1,0,1]
  v_pk_fma_f32 v[132:133], v[132:133], v[2:3], v[2:3] op_sel:[0,0,1] op_sel_hi:[1,0,1]
  v_pk_fma_f32 v[134:135], v[134:135], v[2:3], v[2:3] op_sel:[0,0,1] op_sel_hi:[1,0,1]
  v_pk_fma_f32 v[136:137], v[136:137], v[2:3], v[2:3] op_sel:[0,0,1] op_sel_hi:[1,0,1]
  v_pk_fma_f32 v[138:139], v[138:139], v[2:3], v[2:3] op_sel:[0,0,1] op_sel_hi:[1,0,1]
  v_pk_mul_f32 v[120:121], v[120:121], v[160:161]
  v_pk_mul_f32 v[122:123], v[122:123], v[162:163]
  v_pk_mul_f32 v[124:125], v[124:125], v[164:165]
  v_pk_mul_f32 v[126:127], v[126:127], v[166:167]
  v_pk_mul_f32 v[128:129], v[128:129], v[168:169]
  v_pk_mul_f32 v[130:131], v[130:131], v[170:171]
  v_pk_mul_f32 v[132:133], v[132:133], v[172:173]
  v_pk_mul_f32 v[134:135], v[134:135], v[174:175]
  v_pk_mul_f32 v[136:137], v[136:137], v[176:177]
  v_pk_mul_f32 v[138:139], v[138:139], v[178:179]
  v_exp_f32 v120, v120
  v_exp_f32 v121, v121
  v_exp_f32 v122, v122
  v_exp_f32 v123, v123
  v_exp_f32 v124, v124
  v_exp_f32 v125, v125
  v_exp_f32 v126, v126
  v_exp_f32 v127, v127
  v_exp_f32 v128, v128
  v_exp_f32 v129, v129
  v_exp_f32 v130, v130
  v_exp_f32 v131, v131
  v_exp_f32 v132, v132
  v_exp_f32 v133, v133
  v_exp_f32 v134, v134
  v_exp_f32 v135, v135
  v_exp_f32 v136, v136
  v_exp_f32 v137, v137
  v_exp_f32 v138, v138
  v_exp_f32 v139, v139
  v_pk_fma_f32 v[120:121], v[120:121], v[70:71], v[70:71] op_sel:[0,1,1] op_sel_hi:[1,1,1]
  v_pk_fma_f32 v[122:123], v[122:123], v[70:71], v[70:71] op_sel:[0,1,1] op_sel_hi:[1,1,1]
  v_pk_fma_f32 v[124:125], v[124:125], v[70:71], v[70:71] op_sel:[0,1,1] op_sel_hi:[1,1,1]
  v_pk_fma_f32 v[126:127], v[126:127], v[70:71], v[70:71] op_sel:[0,1,1] op_sel_hi:[1,1,1]
  v_pk_fma_f32 v[128:129], v[128:129], v[70:71], v[70:71] op_sel:[0,1,1] op_sel_hi:[1,1,1]
  v_pk_fma_f32 v[130:131], v[130:131], v[70:71], v[70:71] op_sel:[0,1,1] op_sel_hi:[1,1,1]
  v_pk_fma_f32 v[132:133], v[132:133], v[70:71], v[70:71] op_sel:[0,1,1] op_sel_hi:[1,1,1]
  v_pk_fma_f32 v[134:135], v[134:135], v[70:71], v[70:71] op_sel:[0,1,1] op_sel_hi:[1,1,1]
  v_pk_fma_f32 v[136:137], v[136:137], v[70:71], v[70:71] op_sel:[0,1,1] op_sel_hi:[1,1,1]
  v_pk_fma_f32 v[138:139], v[138:139], v[70:71], v[70:71] op_sel:[0,1,1] op_sel_hi:[1,1,1]
  v_rcp_f32 v120, v120
  v_rcp_f32 v121, v121
  v_rcp_f32 v122, v122
  v_rcp_f32 v123, v123
  v_rcp_f32 v124, v124
  v_rcp_f32 v125, v125
  v_rcp_f32 v126, v126
  v_rcp_f32 v127, v127
  v_rcp_f32 v128, v128
  v_rcp_f32 v129, v129
  v_rcp_f32 v130, v130
  v_rcp_f32 v131, v131
  v_rcp_f32 v132, v132
  v_rcp_f32 v133, v133
  v_rcp_f32 v134, v134
  v_rcp_f32 v135, v135
  v_rcp_f32 v136, v136
  v_rcp_f32 v137, v137
  v_rcp_f32 v138, v138
  v_rcp_f32 v139, v139
  v_pk_mul_f32 v[160:161], v[160:161], v[120:121]
  v_pk_mul_f32 v[162:163], v[162:163], v[122:123]
  v_pk_mul_f32 v[164:165], v[164:165], v[124:125]
  v_pk_mul_f32 v[166:167], v[166:167], v[126:127]
  v_pk_mul_f32 v[168:169], v[168:169], v[128:129]
  v_pk_mul_f32 v[170:171], v[170:171], v[130:131]
  v_pk_mul_f32 v[172:173], v[172:173], v[132:133]
  v_pk_mul_f32 v[174:175], v[174:175], v[134:135]
  v_pk_mul_f32 v[176:177], v[176:177], v[136:137]
  v_pk_mul_f32 v[178:179], v[178:179], v[138:139]
  s_branch C1_pk1
C1_ng1:
  v_pk_mul_f32 v[160:161], v[160:161], v[70:71] op_sel:[0,1] op_sel_hi:[1,1]
  v_pk_mul_f32 v[162:163], v[162:163], v[70:71] op_sel:[0,1] op_sel_hi:[1,1]
  v_pk_mul_f32 v[164:165], v[164:165], v[70:71] op_sel:[0,1] op_sel_hi:[1,1]
  v_pk_mul_f32 v[166:167], v[166:167], v[70:71] op_sel:[0,1] op_sel_hi:[1,1]
  v_pk_mul_f32 v[168:169], v[168:169], v[70:71] op_sel:[0,1] op_sel_hi:[1,1]
  v_pk_mul_f32 v[170:171], v[170:171], v[70:71] op_sel:[0,1] op_sel_hi:[1,1]
  v_pk_mul_f32 v[172:173], v[172:173], v[70:71] op_sel:[0,1] op_sel_hi:[1,1]
  v_pk_mul_f32 v[174:175], v[174:175], v[70:71] op_sel:[0,1] op_sel_hi:[1,1]
  v_pk_mul_f32 v[176:177], v[176:177], v[70:71] op_sel:[0,1] op_sel_hi:[1,1]
  v_pk_mul_f32 v[178:179], v[178:179], v[70:71] op_sel:[0,1] op_sel_hi:[1,1]
C1_pk1:
  v_cvt_pk_bf16_f32 v76, v160, v161
  v_cvt_pk_bf16_f32 v77, v162, v163
  v_cvt_pk_bf16_f32 v78, v164, v165
  v_cvt_pk_bf16_f32 v79, v166, v167
  v_cvt_pk_bf16_f32 v80, v168, v169
  v_cvt_pk_bf16_f32 v81, v170, v171
  v_cvt_pk_bf16_f32 v82, v172, v173
  v_cvt_pk_bf16_f32 v83, v174, v175
  v_cvt_pk_bf16_f32 v96, v176, v177
  v_cvt_pk_bf16_f32 v97, v178, v179
  v_mov_b64 v[98:99], v[96:97]
  v_permlane32_swap_b32 v76, v78
  v_permlane32_swap_b32 v77, v79
  v_permlane32_swap_b32 v80, v82
  v_permlane32_swap_b32 v81, v83
  v_permlane32_swap_b32 v96, v98
  v_permlane32_swap_b32 v97, v99
  buffer_store_dwordx4 v[76:79], v59, s[40:43], s50 offen sc1
  buffer_store_dwordx4 v[80:83], v59, s[40:43], s50 offen offset:1024 sc1
  s_mov_b32 exec_hi, 0
  buffer_store_dwordx4 v[96:99], v59, s[40:43], s51 offen sc1
  s_mov_b32 exec_hi, -1
  v_pk_fma_f32 v[180:181], v[220:221], v[72:73], v[180:181] op_sel_hi:[1,0,1] neg_lo:[0,1,0] neg_hi:[0,1,0]
  v_pk_fma_f32 v[182:183], v[222:223], v[72:73], v[182:183] op_sel_hi:[1,0,1] neg_lo:[0,1,0] neg_hi:[0,1,0]
  v_pk_fma_f32 v[184:185], v[224:225], v[72:73], v[184:185] op_sel_hi:[1,0,1] neg_lo:[0,1,0] neg_hi:[0,1,0]
  v_pk_fma_f32 v[186:187], v[226:227], v[72:73], v[186:187] op_sel_hi:[1,0,1] neg_lo:[0,1,0] neg_hi:[0,1,0]
  v_pk_fma_f32 v[188:189], v[228:229], v[72:73], v[188:189] op_sel_hi:[1,0,1] neg_lo:[0,1,0] neg_hi:[0,1,0]
  v_pk_fma_f32 v[190:191], v[230:231], v[72:73], v[190:191] op_sel_hi:[1,0,1] neg_lo:[0,1,0] neg_hi:[0,1,0]
  v_pk_fma_f32 v[192:193], v[232:233], v[72:73], v[192:193] op_sel_hi:[1,0,1] neg_lo:[0,1,0] neg_hi:[0,1,0]
  v_pk_fma_f32 v[194:195], v[234:235], v[72:73], v[194:195] op_sel_hi:[1,0,1] neg_lo:[0,1,0] neg_hi:[0,1,0]
  v_pk_fma_f32 v[196:197], v[236:237], v[72:73], v[196:197] op_sel_hi:[1,0,1] neg_lo:[0,1,0] neg_hi:[0,1,0]
  v_pk_fma_f32 v[198:199], v[238:239], v[72:73], v[198:199] op_sel_hi:[1,0,1] neg_lo:[0,1,0] neg_hi:[0,1,0]
  s_cmp_lt_u32 s34, 12
  s_cbranch_scc1 C1_ng2
  v_mul_f32 v2, v73, v73
  v_mul_f32 v3, s61, v73
  v_mul_f32 v2, v2, v73
  v_rcp_f32 v73, v73
  v_mul_f32 v2, s60, v2
  v_pk_mul_f32 v[120:121], v[180:181], v[180:181]
  v_pk_mul_f32 v[122:123], v[182:183], v[182:183]
  v_pk_mul_f32 v[124:125], v[184:185], v[184:185]
  v_pk_mul_f32 v[126:127], v[186:187], v[186:187]
  v_pk_mul_f32 v[128:129], v[188:189], v[188:189]
  v_pk_mul_f32 v[130:131], v[190:191], v[190:191]
  v_pk_mul_f32 v[132:133], v[192:193], v[192:193]
  v_pk_mul_f32 v[134:135], v[194:195], v[194:195]
  v_pk_mul_f32 v[136:137], v[196:197], v[196:197]
  v_pk_mul_f32 v[138:139], v[198:199], v[198:199]
  v_pk_fma_f32 v[120:121], v[120:121], v[2:3], v[2:3] op_sel:[0,0,1] op_sel_hi:[1,0,1]
  v_pk_fma_f32 v[122:123], v[122:123], v[2:3], v[2:3] op_sel:[0,0,1] op_sel_hi:[1,0,1]
  v_pk_fma_f32 v[124:125], v[124:125], v[2:3], v[2:3] op_sel:[0,0,1] op_sel_hi:[1,0,1]
  v_pk_fma_f32 v[126:127], v[126:127], v[2:3], v[2:3] op_sel:[0,0,1] op_sel_hi:[1,0,1]
  v_pk_fma_f32 v[128:129], v[128:129], v[2:3], v[2:3] op_sel:[0,0,1] op_sel_hi:[1,0,1]
  v_pk_fma_f32 v[130:131], v[130:131], v[2:3], v[2:3] op_sel:[0,0,1] op_sel_hi:[1,0,1]
  v_pk_fma_f32 v[132:133], v[132:133], v[2:3], v[2:3] op_sel:[0,0,1] op_sel_hi:[1,0,1]
  v_pk_fma_f32 v[134:135], v[134:135], v[2:3], v[2:3] op_sel:[0,0,1] op_sel_hi:[1,0,1]
  v_pk_fma_f32 v[136:137], v[136:137], v[2:3], v[2:3] op_sel:[0,0,1] op_sel_hi:[1,0,1]
  v_pk_fma_f32 v[138:139], v[138:139], v[2:3], v[2:3] op_sel:[0,0,1] op_sel_hi:[1,0,1]
  v_pk_mul_f32 v[120:121], v[120:121], v[180:181]
  v_pk_mul_f32 v[122:123], v[122:123], v[182:183]
  v_pk_mul_f32 v[124:125], v[124:125], v[184:185]
  v_pk_mul_f32 v[126:127], v[126:127], v[186:187]
  v_pk_mul_f32 v[128:129], v[128:129], v[188:189]
  v_pk_mul_f32 v[130:131], v[130:131], v[190:191]
  v_pk_mul_f32 v[132:133], v[132:133], v[192:193]
  v_pk_mul_f32 v[134:135], v[134:135], v[194:195]
  v_pk_mul_f32 v[136:137], v[136:137], v[196:197]
  v_pk_mul_f32 v[138:139], v[138:139], v[198:199]
  v_exp_f32 v120, v120
  v_exp_f32 v121, v121
  v_exp_f32 v122, v122
  v_exp_f32 v123, v123
  v_exp_f32 v124, v124
  v_exp_f32 v125, v125
  v_exp_f32 v126, v126
  v_exp_f32 v127, v127
  v_exp_f32 v128, v128
  v_exp_f32 v129, v129
  v_exp_f32 v130, v130
  v_exp_f32 v131, v131
  v_exp_f32 v132, v132
  v_exp_f32 v133, v133
  v_exp_f32 v134, v134
  v_exp_f32 v135, v135
  v_exp_f32 v136, v136
  v_exp_f32 v137, v137
  v_exp_f32 v138, v138
  v_exp_f32 v139, v139
  v_pk_fma_f32 v[120:121], v[120:121], v[72:73], v[72:73] op_sel:[0,1,1] op_sel_hi:[1,1,1]
  v_pk_fma_f32 v[122:123], v[122:123], v[72:73], v[72:73] op_sel:[0,1,1] op_sel_hi:[1,1,1]
  v_pk_fma_f32 v[124:125], v[124:125], v[72:73], v[72:73] op_sel:[0,1,1] op_sel_hi:[1,1,1]
  v_pk_fma_f32 v[126:127], v[126:127], v[72:73], v[72:73] op_sel:[0,1,1] op_sel_hi:[1,1,1]
  v_pk_fma_f32 v[128:129], v[128:129], v[72:73], v[72:73] op_sel:[0,1,1] op_sel_hi:[1,1,1]
  v_pk_fma_f32 v[130:131], v[130:131], v[72:73], v[72:73] op_sel:[0,1,1] op_sel_hi:[1,1,1]
  v_pk_fma_f32 v[132:133], v[132:133], v[72:73], v[72:73] op_sel:[0,1,1] op_sel_hi:[1,1,1]
  v_pk_fma_f32 v[134:135], v[134:135], v[72:73], v[72:73] op_sel:[0,1,1] op_sel_hi:[1,1,1]
  v_pk_fma_f32 v[136:137], v[136:137], v[72:73], v[72:73] op_sel:[0,1,1] op_sel_hi:[1,1,1]
  v_pk_fma_f32 v[138:139], v[138:139], v[72:73], v[72:73] op_sel:[0,1,1] op_sel_hi:[1,1,1]
  v_rcp_f32 v120, v120
  v_rcp_f32 v121, v121
  v_rcp_f32 v122, v122
  v_rcp_f32 v123, v123
  v_rcp_f32 v124, v124
  v_rcp_f32 v125, v125
  v_rcp_f32 v126, v126
  v_rcp_f32 v127, v127
  v_rcp_f32 v128, v128
  v_rcp_f32 v129, v129
  v_rcp_f32 v130, v130
  v_rcp_f32 v131, v131
  v_rcp_f32 v132, v132
  v_rcp_f32 v133, v133
  v_rcp_f32 v134, v134
  v_rcp_f32 v135, v135
  v_rcp_f32 v136, v136
  v_rcp_f32 v137, v137
  v_rcp_f32 v138, v138
  v_rcp_f32 v139, v139
  v_pk_mul_f32 v[180:181], v[180:181], v[120:121]
  v_pk_mul_f32 v[182:183], v[182:183], v[122:123]
  v_pk_mul_f32 v[184:185], v[184:185], v[124:125]
  v_pk_mul_f32 v[186:187], v[186:187], v[126:127]
  v_pk_mul_f32 v[188:189], v[188:189], v[128:129]
  v_pk_mul_f32 v[190:191], v[190:191], v[130:131]
  v_pk_mul_f32 v[192:193], v[192:193], v[132:133]
  v_pk_mul_f32 v[194:195], v[194:195], v[134:135]
  v_pk_mul_f32 v[196:197], v[196:197], v[136:137]
  v_pk_mul_f32 v[198:199], v[198:199], v[138:139]
  s_branch C1_pk2
C1_ng2:
  v_pk_mul_f32 v[180:181], v[180:181], v[72:73] op_sel:[0,1] op_sel_hi:[1,1]
  v_pk_mul_f32 v[182:183], v[182:183], v[72:73] op_sel:[0,1] op_sel_hi:[1,1]
  v_pk_mul_f32 v[184:185], v[184:185], v[72:73] op_sel:[0,1] op_sel_hi:[1,1]
  v_pk_mul_f32 v[186:187], v[186:187], v[72:73] op_sel:[0,1] op_sel_hi:[1,1]
  v_pk_mul_f32 v[188:189], v[188:189], v[72:73] op_sel:[0,1] op_sel_hi:[1,1]
  v_pk_mul_f32 v[190:191], v[190:191], v[72:73] op_sel:[0,1] op_sel_hi:[1,1]
  v_pk_mul_f32 v[192:193], v[192:193], v[72:73] op_sel:[0,1] op_sel_hi:[1,1]
  v_pk_mul_f32 v[194:195], v[194:195], v[72:73] op_sel:[0,1] op_sel_hi:[1,1]
  v_pk_mul_f32 v[196:197], v[196:197], v[72:73] op_sel:[0,1] op_sel_hi:[1,1]
  v_pk_mul_f32 v[198:199], v[198:199], v[72:73] op_sel:[0,1] op_sel_hi:[1,1]
C1_pk2:
  v_cvt_pk_bf16_f32 v84, v180, v181
  v_cvt_pk_bf16_f32 v85, v182, v183
  v_cvt_pk_bf16_f32 v86, v184, v185
  v_cvt_pk_bf16_f32 v87, v186, v187
  v_cvt_pk_bf16_f32 v88, v188, v189
  v_cvt_pk_bf16_f32 v89, v190, v191
  v_cvt_pk_bf16_f32 v90, v192, v193
  v_cvt_pk_bf16_f32 v91, v194, v195
  v_cvt_pk_bf16_f32 v92, v196, v197
  v_cvt_pk_bf16_f32 v93, v198, v199
  v_mov_b64 v[94:95], v[92:93]
  v_permlane32_swap_b32 v84, v86
  v_permlane32_swap_b32 v85, v87
  v_permlane32_swap_b32 v88, v90
  v_permlane32_swap_b32 v89, v91
  v_permlane32_swap_b32 v92, v94
  v_permlane32_swap_b32 v93, v95
  buffer_store_dwordx4 v[84:87], v60, s[40:43], s50 offen sc1
  buffer_store_dwordx4 v[88:91], v60, s[40:43], s50 offen offset:1024 sc1
  s_mov_b32 exec_hi, 0
  buffer_store_dwordx4 v[92:95], v60, s[40:43], s51 offen sc1
  s_mov_b32 exec_hi, -1
  v_pk_fma_f32 v[200:201], v[220:221], v[74:75], v[200:201] op_sel_hi:[1,0,1] neg_lo:[0,1,0] neg_hi:[0,1,0]
  v_pk_fma_f32 v[202:203], v[222:223], v[74:75], v[202:203] op_sel_hi:[1,0,1] neg_lo:[0,1,0] neg_hi:[0,1,0]
  v_pk_fma_f32 v[204:205], v[224:225], v[74:75], v[204:205] op_sel_hi:[1,0,1] neg_lo:[0,1,0] neg_hi:[0,1,0]
  v_pk_fma_f32 v[206:207], v[226:227], v[74:75], v[206:207] op_sel_hi:[1,0,1] neg_lo:[0,1,0] neg_hi:[0,1,0]
  v_pk_fma_f32 v[208:209], v[228:229], v[74:75], v[208:209] op_sel_hi:[1,0,1] neg_lo:[0,1,0] neg_hi:[0,1,0]
  v_pk_fma_f32 v[210:211], v[230:231], v[74:75], v[210:211] op_sel_hi:[1,0,1] neg_lo:[0,1,0] neg_hi:[0,1,0]
  v_pk_fma_f32 v[212:213], v[232:233], v[74:75], v[212:213] op_sel_hi:[1,0,1] neg_lo:[0,1,0] neg_hi:[0,1,0]
  v_pk_fma_f32 v[214:215], v[234:235], v[74:75], v[214:215] op_sel_hi:[1,0,1] neg_lo:[0,1,0] neg_hi:[0,1,0]
  v_pk_fma_f32 v[216:217], v[236:237], v[74:75], v[216:217] op_sel_hi:[1,0,1] neg_lo:[0,1,0] neg_hi:[0,1,0]
  v_pk_fma_f32 v[218:219], v[238:239], v[74:75], v[218:219] op_sel_hi:[1,0,1] neg_lo:[0,1,0] neg_hi:[0,1,0]
  s_cmp_lt_u32 s34, 12
  s_cbranch_scc1 C1_ng3
  v_mul_f32 v2, v75, v75
  v_mul_f32 v3, s61, v75
  v_mul_f32 v2, v2, v75
  v_rcp_f32 v75, v75
  v_mul_f32 v2, s60, v2
  v_pk_mul_f32 v[120:121], v[200:201], v[200:201]
  v_pk_mul_f32 v[122:123], v[202:203], v[202:203]
  v_pk_mul_f32 v[124:125], v[204:205], v[204:205]
  v_pk_mul_f32 v[126:127], v[206:207], v[206:207]
  v_pk_mul_f32 v[128:129], v[208:209], v[208:209]
  v_pk_mul_f32 v[130:131], v[210:211], v[210:211]
  v_pk_mul_f32 v[132:133], v[212:213], v[212:213]
  v_pk_mul_f32 v[134:135], v[214:215], v[214:215]
  v_pk_mul_f32 v[136:137], v[216:217], v[216:217]
  v_pk_mul_f32 v[138:139], v[218:219], v[218:219]
  v_pk_fma_f32 v[120:121], v[120:121], v[2:3], v[2:3] op_sel:[0,0,1] op_sel_hi:[1,0,1]
  v_pk_fma_f32 v[122:123], v[122:123], v[2:3], v[2:3] op_sel:[0,0,1] op_sel_hi:[1,0,1]
  v_pk_fma_f32 v[124:125], v[124:125], v[2:3], v[2:3] op_sel:[0,0,1] op_sel_hi:[1,0,1]
  v_pk_fma_f32 v[126:127], v[126:127], v[2:3], v[2:3] op_sel:[0,0,1] op_sel_hi:[1,0,1]
  v_pk_fma_f32 v[128:129], v[128:129], v[2:3], v[2:3] op_sel:[0,0,1] op_sel_hi:[1,0,1]
  v_pk_fma_f32 v[130:131], v[130:131], v[2:3], v[2:3] op_sel:[0,0,1] op_sel_hi:[1,0,1]
  v_pk_fma_f32 v[132:133], v[132:133], v[2:3], v[2:3] op_sel:[0,0,1] op_sel_hi:[1,0,1]
  v_pk_fma_f32 v[134:135], v[134:135], v[2:3], v[2:3] op_sel:[0,0,1] op_sel_hi:[1,0,1]
  v_pk_fma_f32 v[136:137], v[136:137], v[2:3], v[2:3] op_sel:[0,0,1] op_sel_hi:[1,0,1]
  v_pk_fma_f32 v[138:139], v[138:139], v[2:3], v[2:3] op_sel:[0,0,1] op_sel_hi:[1,0,1]
  v_pk_mul_f32 v[120:121], v[120:121], v[200:201]
  v_pk_mul_f32 v[122:123], v[122:123], v[202:203]
  v_pk_mul_f32 v[124:125], v[124:125], v[204:205]
  v_pk_mul_f32 v[126:127], v[126:127], v[206:207]
  v_pk_mul_f32 v[128:129], v[128:129], v[208:209]
  v_pk_mul_f32 v[130:131], v[130:131], v[210:211]
  v_pk_mul_f32 v[132:133], v[132:133], v[212:213]
  v_pk_mul_f32 v[134:135], v[134:135], v[214:215]
  v_pk_mul_f32 v[136:137], v[136:137], v[216:217]
  v_pk_mul_f32 v[138:139], v[138:139], v[218:219]
  v_exp_f32 v120, v120
  v_exp_f32 v121, v121
  v_exp_f32 v122, v122
  v_exp_f32 v123, v123
  v_exp_f32 v124, v124
  v_exp_f32 v125, v125
  v_exp_f32 v126, v126
  v_exp_f32 v127, v127
  v_exp_f32 v128, v128
  v_exp_f32 v129, v129
  v_exp_f32 v130, v130
  v_exp_f32 v131, v131
  v_exp_f32 v132, v132
  v_exp_f32 v133, v133
  v_exp_f32 v134, v134
  v_exp_f32 v135, v135
  v_exp_f32 v136, v136
  v_exp_f32 v137, v137
  v_exp_f32 v138, v138
  v_exp_f32 v139, v139
  v_pk_fma_f32 v[120:121], v[120:121], v[74:75], v[74:75] op_sel:[0,1,1] op_sel_hi:[1,1,1]
  v_pk_fma_f32 v[122:123], v[122:123], v[74:75], v[74:75] op_sel:[0,1,1] op_sel_hi:[1,1,1]
  v_pk_fma_f32 v[124:125], v[124:125], v[74:75], v[74:75] op_sel:[0,1,1] op_sel_hi:[1,1,1]
  v_pk_fma_f32 v[126:127], v[126:127], v[74:75], v[74:75] op_sel:[0,1,1] op_sel_hi:[1,1,1]
  v_pk_fma_f32 v[128:129], v[128:129], v[74:75], v[74:75] op_sel:[0,1,1] op_sel_hi:[1,1,1]
  v_pk_fma_f32 v[130:131], v[130:131], v[74:75], v[74:75] op_sel:[0,1,1] op_sel_hi:[1,1,1]
  v_pk_fma_f32 v[132:133], v[132:133], v[74:75], v[74:75] op_sel:[0,1,1] op_sel_hi:[1,1,1]
  v_pk_fma_f32 v[134:135], v[134:135], v[74:75], v[74:75] op_sel:[0,1,1] op_sel_hi:[1,1,1]
  v_pk_fma_f32 v[136:137], v[136:137], v[74:75], v[74:75] op_sel:[0,1,1] op_sel_hi:[1,1,1]
  v_pk_fma_f32 v[138:139], v[138:139], v[74:75], v[74:75] op_sel:[0,1,1] op_sel_hi:[1,1,1]
  v_rcp_f32 v120, v120
  v_rcp_f32 v121, v121
  v_rcp_f32 v122, v122
  v_rcp_f32 v123, v123
  v_rcp_f32 v124, v124
  v_rcp_f32 v125, v125
  v_rcp_f32 v126, v126
  v_rcp_f32 v127, v127
  v_rcp_f32 v128, v128
  v_rcp_f32 v129, v129
  v_rcp_f32 v130, v130
  v_rcp_f32 v131, v131
  v_rcp_f32 v132, v132
  v_rcp_f32 v133, v133
  v_rcp_f32 v134, v134
  v_rcp_f32 v135, v135
  v_rcp_f32 v136, v136
  v_rcp_f32 v137, v137
  v_rcp_f32 v138, v138
  v_rcp_f32 v139, v139
  v_pk_mul_f32 v[200:201], v[200:201], v[120:121]
  v_pk_mul_f32 v[202:203], v[202:203], v[122:123]
  v_pk_mul_f32 v[204:205], v[204:205], v[124:125]
  v_pk_mul_f32 v[206:207], v[206:207], v[126:127]
  v_pk_mul_f32 v[208:209], v[208:209], v[128:129]
  v_pk_mul_f32 v[210:211], v[210:211], v[130:131]
  v_pk_mul_f32 v[212:213], v[212:213], v[132:133]
  v_pk_mul_f32 v[214:215], v[214:215], v[134:135]
  v_pk_mul_f32 v[216:217], v[216:217], v[136:137]
  v_pk_mul_f32 v[218:219], v[218:219], v[138:139]
  s_branch C1_pk3
C1_ng3:
  v_pk_mul_f32 v[200:201], v[200:201], v[74:75] op_sel:[0,1] op_sel_hi:[1,1]
  v_pk_mul_f32 v[202:203], v[202:203], v[74:75] op_sel:[0,1] op_sel_hi:[1,1]
  v_pk_mul_f32 v[204:205], v[204:205], v[74:75] op_sel:[0,1] op_sel_hi:[1,1]
  v_pk_mul_f32 v[206:207], v[206:207], v[74:75] op_sel:[0,1] op_sel_hi:[1,1]
  v_pk_mul_f32 v[208:209], v[208:209], v[74:75] op_sel:[0,1] op_sel_hi:[1,1]
  v_pk_mul_f32 v[210:211], v[210:211], v[74:75] op_sel:[0,1] op_sel_hi:[1,1]
  v_pk_mul_f32 v[212:213], v[212:213], v[74:75] op_sel:[0,1] op_sel_hi:[1,1]
  v_pk_mul_f32 v[214:215], v[214:215], v[74:75] op_sel:[0,1] op_sel_hi:[1,1]
  v_pk_mul_f32 v[216:217], v[216:217], v[74:75] op_sel:[0,1] op_sel_hi:[1,1]
  v_pk_mul_f32 v[218:219], v[218:219], v[74:75] op_sel:[0,1] op_sel_hi:[1,1]
C1_pk3:
  v_cvt_pk_bf16_f32 v76, v200, v201
  v_cvt_pk_bf16_f32 v77, v202, v203
  v_cvt_pk_bf16_f32 v78, v204, v205
  v_cvt_pk_bf16_f32 v79, v206, v207
  v_cvt_pk_bf16_f32 v80, v208, v209
  v_cvt_pk_bf16_f32 v81, v210, v211
  v_cvt_pk_bf16_f32 v82, v212, v213
  v_cvt_pk_bf16_f32 v83, v214, v215
  v_cvt_pk_bf16_f32 v96, v216, v217
  v_cvt_pk_bf16_f32 v97, v218, v219
  v_mov_b64 v[98:99], v[96:97]
  v_permlane32_swap_b32 v76, v78
  v_permlane32_swap_b32 v77, v79
  v_permlane32_swap_b32 v80, v82
  v_permlane32_swap_b32 v81, v83
  v_permlane32_swap_b32 v96, v98
  v_permlane32_swap_b32 v97, v99
  buffer_store_dwordx4 v[76:79], v61, s[40:43], s50 offen sc1
  buffer_store_dwordx4 v[80:83], v61, s[40:43], s50 offen offset:1024 sc1
  s_mov_b32 exec_hi, 0
  buffer_store_dwordx4 v[96:99], v61, s[40:43], s51 offen sc1
  s_mov_b32 exec_hi, -1
  v_mov_b32 v2, 154888
  v_mov_b32 v3, 1
  s_waitcnt vmcnt(0)
  s_mov_b64 exec, 1
  buffer_store_dword v12, off, s[28:31], s58 sc1
  ds_add_u32 v2, v3
  s_mov_b64 exec, -1
  s_add_u32 s58, s58, 4096
  s_mov_b32 s40, s4
  s_mov_b32 s41, s5
  s_mov_b32 s42, 2621440
  s_mov_b32 s43, 0x20000
  buffer_load_dwordx2 v[16:17], v42, s[40:43], s54 offen offset:0
  buffer_load_dwordx2 v[18:19], v42, s[40:43], s54 offen offset:32
  buffer_load_dwordx2 v[20:21], v42, s[40:43], s54 offen offset:64
  buffer_load_dwordx2 v[22:23], v42, s[40:43], s54 offen offset:96
  buffer_load_dwordx2 v[24:25], v42, s[40:43], s55 offen
  v_and_b32 v10, 127, v43
  v_lshlrev_b32 v10, 3, v10
  v_add_u32 v10, 152576, v10
  ds_read_b64 v[52:53], v10
  s_waitcnt vmcnt(0)
  v_lshlrev_b32 v116, 16, v16
  v_and_b32 v117, 0xffff0000, v16
  v_lshlrev_b32 v118, 16, v17
  v_and_b32 v119, 0xffff0000, v17
  v_lshlrev_b32 v120, 16, v18
  v_and_b32 v121, 0xffff0000, v18
  v_lshlrev_b32 v122, 16, v19
  v_and_b32 v123, 0xffff0000, v19
  v_lshlrev_b32 v124, 16, v20
  v_and_b32 v125, 0xffff0000, v20
  v_lshlrev_b32 v126, 16, v21
  v_and_b32 v127, 0xffff0000, v21
  v_lshlrev_b32 v128, 16, v22
  v_and_b32 v129, 0xffff0000, v22
  v_lshlrev_b32 v130, 16, v23
  v_and_b32 v131, 0xffff0000, v23
  v_lshlrev_b32 v132, 16, v24
  v_and_b32 v133, 0xffff0000, v24
  v_lshlrev_b32 v134, 16, v25
  v_and_b32 v135, 0xffff0000, v25
  s_waitcnt lgkmcnt(0)
  v_pk_add_f32 v[116:117], v[116:117], v[52:53] op_sel_hi:[1,0] neg_lo:[0,1] neg_hi:[0,1]
  v_pk_add_f32 v[118:119], v[118:119], v[52:53] op_sel_hi:[1,0] neg_lo:[0,1] neg_hi:[0,1]
  v_pk_add_f32 v[120:121], v[120:121], v[52:53] op_sel_hi:[1,0] neg_lo:[0,1] neg_hi:[0,1]
  v_pk_add_f32 v[122:123], v[122:123], v[52:53] op_sel_hi:[1,0] neg_lo:[0,1] neg_hi:[0,1]
  v_pk_add_f32 v[124:125], v[124:125], v[52:53] op_sel_hi:[1,0] neg_lo:[0,1] neg_hi:[0,1]
  v_pk_add_f32 v[126:127], v[126:127], v[52:53] op_sel_hi:[1,0] neg_lo:[0,1] neg_hi:[0,1]
  v_pk_add_f32 v[128:129], v[128:129], v[52:53] op_sel_hi:[1,0] neg_lo:[0,1] neg_hi:[0,1]
  v_pk_add_f32 v[130:131], v[130:131], v[52:53] op_sel_hi:[1,0] neg_lo:[0,1] neg_hi:[0,1]
  v_pk_add_f32 v[132:133], v[132:133], v[52:53] op_sel_hi:[1,0] neg_lo:[0,1] neg_hi:[0,1]
  v_pk_add_f32 v[134:135], v[134:135], v[52:53] op_sel_hi:[1,0] neg_lo:[0,1] neg_hi:[0,1]
  v_pk_mul_f32 v[116:117], v[116:117], v[52:53] op_sel:[0,1] op_sel_hi:[1,1]
  v_pk_mul_f32 v[118:119], v[118:119], v[52:53] op_sel:[0,1] op_sel_hi:[1,1]
  v_pk_mul_f32 v[120:121], v[120:121], v[52:53] op_sel:[0,1] op_sel_hi:[1,1]
  v_pk_mul_f32 v[122:123], v[122:123], v[52:53] op_sel:[0,1] op_sel_hi:[1,1]
  v_pk_mul_f32 v[124:125], v[124:125], v[52:53] op_sel:[0,1] op_sel_hi:[1,1]
  v_pk_mul_f32 v[126:127], v[126:127], v[52:53] op_sel:[0,1] op_sel_hi:[1,1]
  v_pk_mul_f32 v[128:129], v[128:129], v[52:53] op_sel:[0,1] op_sel_hi:[1,1]
  v_pk_mul_f32 v[130:131], v[130:131], v[52:53] op_sel:[0,1] op_sel_hi:[1,1]
  v_pk_mul_f32 v[132:133], v[132:133], v[52:53] op_sel:[0,1] op_sel_hi:[1,1]
  v_pk_mul_f32 v[134:135], v[134:135], v[52:53] op_sel:[0,1] op_sel_hi:[1,1]
  s_add_u32 s40, s24, 16777216
  s_addc_u32 s41, s25, 0
  s_mov_b32 s42, 2621440
  s_mov_b32 s43, 0x20000
  s_mov_b32 s48, 5
CS_in:
  v_mov_b64 v[136:137], 0
  v_mov_b64 v[138:139], 0
  v_mov_b64 v[140:141], 0
  v_mov_b64 v[142:143], 0
  v_mov_b64 v[144:145], 0
  v_mov_b64 v[146:147], 0
  v_mov_b64 v[148:149], 0
  v_mov_b64 v[150:151], 0
  v_mov_b64 v[152:153], 0
  v_mov_b64 v[154:155], 0
  v_add_u32 v48, s46, v38
  v_add_u32 v49, s46, v39
  v_add_u32 v50, s47, v40
  v_add_u32 v51, s47, v41
  s_barrier
  ds_read_b128 v[60:63], v48 offset:0
  ds_read_b64_tr_b16 v[76:77], v50 offset:0
  ds_read_b64_tr_b16 v[78:79], v50 offset:1280
  ds_read_b128 v[64:67], v49 offset:0
  ds_read_b64_tr_b16 v[80:81], v50 offset:32
  ds_read_b64_tr_b16 v[82:83], v50 offset:1312
  ds_read_b64_tr_b16 v[84:85], v50 offset:64
  ds_read_b64_tr_b16 v[86:87], v50 offset:1344
  ds_read_b64_tr_b16 v[88:89], v50 offset:96
  ds_read_b64_tr_b16 v[90:91], v50 offset:1376
  ds_read_b64_tr_b16 v[92:93], v51 offset:0
  ds_read_b64_tr_b16 v[94:95], v51 offset:1280
CS_l:
  s_cmp_eq_u32 s48, s37
  s_cbranch_scc1 CS_sig
CS_r:
  s_add_u32 s46, s46, 16384
  s_cmp_eq_u32 s46, 151552
  s_cselect_b32 s46, 102400, s46
  s_add_u32 s47, s47, 20480
  s_cmp_eq_u32 s47, 102400
  s_cselect_b32 s47, 0, s47
  s_waitcnt lgkmcnt(0)
  v_mfma_f32_16x16x32_bf16 v[116:119], v[76:79], v[60:63], v[116:119]
  ds_read_b128 v[68:71], v48 offset:1024
  ds_read_b64_tr_b16 v[96:97], v50 offset:5120
  v_mfma_f32_16x16x32_bf16 v[136:139], v[76:79], v[64:67], v[136:139]
  ds_read_b64_tr_b16 v[98:99], v50 offset:6400
  ds_read_b128 v[72:75], v49 offset:1024
  v_mfma_f32_16x16x32_bf16 v[120:123], v[80:83], v[60:63], v[120:123]
  ds_read_b64_tr_b16 v[100:101], v50 offset:5152
  ds_read_b64_tr_b16 v[102:103], v50 offset:6432
  v_mfma_f32_16x16x32_bf16 v[140:143], v[80:83], v[64:67], v[140:143]
  ds_read_b64_tr_b16 v[104:105], v50 offset:5184
  ds_read_b64_tr_b16 v[106:107], v50 offset:6464
  v_mfma_f32_16x16x32_bf16 v[124:127], v[84:87], v[60:63], v[124:127]
  ds_read_b64_tr_b16 v[108:109], v50 offset:5216
  ds_read_b64_tr_b16 v[110:111], v50 offset:6496
  v_mfma_f32_16x16x32_bf16 v[144:147], v[84:87], v[64:67], v[144:147]
  ds_read_b64_tr_b16 v[112:113], v51 offset:5120
  ds_read_b64_tr_b16 v[114:115], v51 offset:6400
  v_mfma_f32_16x16x32_bf16 v[128:131], v[88:91], v[60:63], v[128:131]
  v_add_u32 v48, s46, v38
  v_add_u32 v49, s46, v39
  v_mfma_f32_16x16x32_bf16 v[148:151], v[88:91], v[64:67], v[148:151]
  v_add_u32 v50, s47, v40
  v_add_u32 v51, s47, v41
  v_mfma_f32_16x16x32_bf16 v[132:135], v[92:95], v[60:63], v[132:135]
  v_mfma_f32_16x16x32_bf16 v[152:155], v[92:95], v[64:67], v[152:155]
  s_waitcnt lgkmcnt(0)
  s_barrier
  v_mfma_f32_16x16x32_bf16 v[116:119], v[96:99], v[68:71], v[116:119]
  ds_read_b128 v[60:63], v48 offset:0
  ds_read_b64_tr_b16 v[76:77], v50 offset:0
  v_mfma_f32_16x16x32_bf16 v[136:139], v[96:99], v[72:75], v[136:139]
  ds_read_b64_tr_b16 v[78:79], v50 offset:1280
  ds_read_b128 v[64:67], v49 offset:0
  v_mfma_f32_16x16x32_bf16 v[120:123], v[100:103], v[68:71], v[120:123]
  ds_read_b64_tr_b16 v[80:81], v50 offset:32
  ds_read_b64_tr_b16 v[82:83], v50 offset:1312
  v_mfma_f32_16x16x32_bf16 v[140:143], v[100:103], v[72:75], v[140:143]
  ds_read_b64_tr_b16 v[84:85], v50 offset:64
  ds_read_b64_tr_b16 v[86:87], v50 offset:1344
  v_mfma_f32_16x16x32_bf16 v[124:127], v[104:107], v[68:71], v[124:127]
  ds_read_b64_tr_b16 v[88:89], v50 offset:96
  ds_read_b64_tr_b16 v[90:91], v50 offset:1376
  v_mfma_f32_16x16x32_bf16 v[144:147], v[104:107], v[72:75], v[144:147]
  ds_read_b64_tr_b16 v[92:93], v51 offset:0
  ds_read_b64_tr_b16 v[94:95], v51 offset:1280
  v_mfma_f32_16x16x32_bf16 v[128:131], v[108:111], v[68:71], v[128:131]
  s_sub_u32 s48, s48, 1
  s_cmp_lg_u32 s48, 0
  v_mfma_f32_16x16x32_bf16 v[148:151], v[108:111], v[72:75], v[148:151]
  v_mfma_f32_16x16x32_bf16 v[132:135], v[112:115], v[68:71], v[132:135]
  v_mfma_f32_16x16x32_bf16 v[152:155], v[112:115], v[72:75], v[152:155]
  s_cbranch_scc1 CS_l
  s_add_u32 s49, s49, 1
  s_cmp_eq_u32 s49, 2
  s_cbranch_scc1 CA3
  s_mul_i32 s35, s32, 10240
  s_add_u32 s35, s35, 102400
  v_lshl_add_u32 v10, v1, 4, s35
  s_xor_b32 s35, s32, 2
  s_mul_i32 s35, s35, 10240
  s_add_u32 s35, s35, 102400
  v_lshl_add_u32 v11, v1, 4, s35
  ds_write_b128 v10, v[136:139] offset:0
  ds_write_b128 v10, v[140:143] offset:1024
  ds_write_b128 v10, v[144:147] offset:2048
  ds_write_b128 v10, v[148:151] offset:3072
  ds_write_b128 v10, v[152:155] offset:4096
  s_cmp_eq_u32 s49, 3
  s_cbranch_scc1 CS4
  v_lshrrev_b32 v10, 4, v43
  v_mul_u32_u24 v10, 20480, v10
  v_lshl_add_u32 v48, v1, 4, v10
  s_and_b32 s36, s34, 7
  s_lshl_b32 s35, s33, 3
  s_add_u32 s36, s36, s35
  s_lshl_b32 s36, s36, 10
  s_add_u32 s36, s36, 65536
  v_and_b32 v49, 127, v43
  v_lshlrev_b32 v49, 3, v49
  s_waitcnt lgkmcnt(0)
  s_barrier
  ds_read_b128 v[76:79], v11 offset:0
  ds_read_b128 v[80:83], v11 offset:1024
  ds_read_b128 v[84:87], v11 offset:2048
  ds_read_b128 v[88:91], v11 offset:3072
  ds_read_b128 v[92:95], v11 offset:4096
  s_waitcnt lgkmcnt(0)
  v_pk_add_f32 v[116:117], v[116:117], v[76:77]
  v_pk_add_f32 v[118:119], v[118:119], v[78:79]
  v_pk_add_f32 v[120:121], v[120:121], v[80:81]
  v_pk_add_f32 v[122:123], v[122:123], v[82:83]
  v_pk_add_f32 v[124:125], v[124:125], v[84:85]
  v_pk_add_f32 v[126:127], v[126:127], v[86:87]
  v_pk_add_f32 v[128:129], v[128:129], v[88:89]
  v_pk_add_f32 v[130:131], v[130:131], v[90:91]
  v_pk_add_f32 v[132:133], v[132:133], v[92:93]
  v_pk_add_f32 v[134:135], v[134:135], v[94:95]
  v_cvt_pk_bf16_f32 v28, v116, v117
  v_cvt_pk_bf16_f32 v29, v118, v119
  v_cvt_pk_bf16_f32 v30, v120, v121
  v_cvt_pk_bf16_f32 v31, v122, v123
  v_cvt_pk_bf16_f32 v32, v124, v125
  v_cvt_pk_bf16_f32 v33, v126, v127
  v_cvt_pk_bf16_f32 v34, v128, v129
  v_cvt_pk_bf16_f32 v35, v130, v131
  v_cvt_pk_bf16_f32 v36, v132, v133
  v_cvt_pk_bf16_f32 v37, v134, v135
  v_mov_b64 v[176:177], v[28:29]
  v_mov_b64 v[178:179], v[30:31]
  v_mov_b64 v[180:181], v[32:33]
  v_mov_b64 v[182:183], v[34:35]
  v_mov_b64 v[184:185], v[36:37]
  v_mov_b64 v[186:187], v[36:37]
  v_permlane32_swap_b32 v176, v178
  v_permlane32_swap_b32 v177, v179
  v_permlane32_swap_b32 v180, v182
  v_permlane32_swap_b32 v181, v183
  v_permlane32_swap_b32 v184, v186
  v_permlane32_swap_b32 v185, v187
  buffer_store_dwordx4 v[176:179], v48, s[40:43], s56 offen sc1
  buffer_store_dwordx4 v[180:183], v48, s[40:43], s56 offen offset:1024 sc1
  s_mov_b32 exec_hi, 0
  buffer_store_dwordx4 v[184:187], v48, s[40:43], s57 offen sc1
  s_mov_b32 exec_hi, -1
  v_pk_add_f32 v[54:55], v[116:117], v[118:119]
  v_pk_mul_f32 v[56:57], v[116:117], v[116:117]
  v_pk_fma_f32 v[56:57], v[118:119], v[118:119], v[56:57]
  v_pk_add_f32 v[54:55], v[54:55], v[120:121]
  v_pk_fma_f32 v[56:57], v[120:121], v[120:121], v[56:57]
  v_pk_add_f32 v[54:55], v[54:55], v[122:123]
  v_pk_fma_f32 v[56:57], v[122:123], v[122:123], v[56:57]
  v_pk_add_f32 v[54:55], v[54:55], v[124:125]
  v_pk_fma_f32 v[56:57], v[124:125], v[124:125], v[56:57]
  v_pk_add_f32 v[54:55], v[54:55], v[126:127]
  v_pk_fma_f32 v[56:57], v[126:127], v[126:127], v[56:57]
  v_pk_add_f32 v[54:55], v[54:55], v[128:129]
  v_pk_fma_f32 v[56:57], v[128:129], v[128:129], v[56:57]
  v_pk_add_f32 v[54:55], v[54:55], v[130:131]
  v_pk_fma_f32 v[56:57], v[130:131], v[130:131], v[56:57]
  v_pk_add_f32 v[54:55], v[54:55], v[132:133]
  v_pk_fma_f32 v[56:57], v[132:133], v[132:133], v[56:57]
  v_pk_add_f32 v[54:55], v[54:55], v[134:135]
  v_pk_fma_f32 v[56:57], v[134:135], v[134:135], v[56:57]
  v_add_f32 v54, v54, v55
  v_add_f32 v55, v56, v57
  v_mov_b64 v[56:57], v[54:55]
  s_nop 1
  v_permlane32_swap_b32 v54, v56
  v_permlane32_swap_b32 v55, v57
  v_pk_add_f32 v[54:55], v[54:55], v[56:57]
  v_mov_b64 v[56:57], v[54:55]
  s_nop 1
  v_permlane16_swap_b32 v54, v56
  v_permlane16_swap_b32 v55, v57
  v_pk_add_f32 v[54:55], v[54:55], v[56:57]
  s_mov_b64 exec, 0xffff
  buffer_store_dwordx2 v[54:55], v49, s[28:31], s36 offen sc1
  s_mov_b64 exec, -1
  v_lshlrev_b32 v60, 1, v8
  v_lshrrev_b32 v62, 4, v60
  v_mul_u32_u24 v62, 5120, v62
  v_and_b32 v60, 15, v60
  v_lshl_add_u32 v63, v60, 4, v62
  s_lshl_b32 s48, s33, 2
  s_lshr_b32 s35, s34, 2
  s_add_u32 s48, s48, s35
  v_lshlrev_b32 v60, 1, v8
  v_add_u32 v60, -16, v60
  v_max_i32 v60, 0, v60
  v_lshrrev_b32 v62, 4, v60
  v_mul_u32_u24 v62, 5120, v62
  v_and_b32 v60, 15, v60
  v_lshl_add_u32 v66, v60, 4, v62
  v_add_u32 v66, 10240, v66
  v_lshrrev_b32 v60, 2, v1
  v_lshlrev_b32 v60, 1, v60
  v_add_u32 v60, -16, v60
  v_max_i32 v60, 0, v60
  v_lshrrev_b32 v62, 4, v60
  v_mul_u32_u24 v62, 5120, v62
  v_and_b32 v60, 15, v60
  v_lshl_add_u32 v68, v60, 4, v62
  v_add_u32 v68, 25600, v68
  v_lshlrev_b32 v60, 1, v8
  v_add_u32 v60, 16, v60
  v_max_i32 v60, 0, v60
  v_lshrrev_b32 v62, 4, v60
  v_mul_u32_u24 v62, 5120, v62
  v_and_b32 v60, 15, v60
  v_lshl_add_u32 v67, v60, 4, v62
  v_add_u32 v67, 10240, v67
  v_lshrrev_b32 v60, 2, v1
  v_lshlrev_b32 v60, 1, v60
  v_add_u32 v60, 16, v60
  v_max_i32 v60, 0, v60
  v_lshrrev_b32 v62, 4, v60
  v_mul_u32_u24 v62, 5120, v62
  v_and_b32 v60, 15, v60
  v_lshl_add_u32 v69, v60, 4, v62
  v_add_u32 v69, 25600, v69
  v_lshlrev_b32 v60, 2, v9
  v_sub_u32 v60, v8, v60
  v_mov_b32 v61, 0xf149f2ca
  s_cmp_eq_u32 s48, 0
  s_cselect_b32 s35, 0, 8
  v_add_u32 v62, 16, v60
  v_cmp_gt_u32 vcc, s35, v62
  s_nop 1
  v_cndmask_b32 v72, v61, 0, vcc
  v_add_u32 v62, 15, v60
  v_cmp_gt_u32 vcc, s35, v62
  s_nop 1
  v_cndmask_b32 v73, v61, 0, vcc
  v_add_u32 v62, 14, v60
  v_cmp_gt_u32 vcc, s35, v62
  s_nop 1
  v_cndmask_b32 v74, v61, 0, vcc
  v_add_u32 v62, 13, v60
  v_cmp_gt_u32 vcc, s35, v62
  s_nop 1
  v_cndmask_b32 v75, v61, 0, vcc
  v_add_u32 v62, 0, v60
  v_cmp_gt_u32 vcc, 8, v62
  s_nop 1
  v_cndmask_b32 v76, v61, 0, vcc
  v_add_u32 v62, -1, v60
  v_cmp_gt_u32 vcc, 8, v62
  s_nop 1
  v_cndmask_b32 v77, v61, 0, vcc
  v_add_u32 v62, -2, v60
  v_cmp_gt_u32 vcc, 8, v62
  s_nop 1
  v_cndmask_b32 v78, v61, 0, vcc
  v_add_u32 v62, -3, v60
  v_cmp_gt_u32 vcc, 8, v62
  s_nop 1
  v_cndmask_b32 v79, v61, 0, vcc
  v_mov_b64 v[82:83], 0
  s_mov_b32 s53, 0x3ea52b5c
  s_mov_b32 s48, 0
  v_mov_b32 v2, 154888
  v_mov_b32 v3, 1
  s_waitcnt vmcnt(0)
  s_mov_b64 exec, 1
  buffer_store_dword v12, off, s[28:31], s58 sc1
  ds_add_u32 v2, v3
  s_mov_b64 exec, -1
  s_add_u32 s58, s58, 4096
CAT_l:
  s_lshr_b32 s51, s48, 1
  s_lshl_b32 s35, s32, 1
  s_add_u32 s51, s51, s35
  s_mul_i32 s51, s51, 5
  s_and_b32 s52, s48, 1
  s_lshl_b32 s52, s52, 4
  s_add_u32 s35, s51, 4
  s_lshr_b32 s50, s35, 3
  s_lshl_b32 s50, s50, 10
  s_and_b32 s36, s35, 1
  s_lshl_b32 s36, s36, 8
  s_add_u32 s50, s50, s36
  s_and_b32 s36, s35, 4
  s_lshl_b32 s36, s36, 7
  s_add_u32 s50, s50, s36
  s_and_b32 s36, s35, 2
  s_lshl_b32 s36, s36, 2
  s_add_u32 s50, s50, s36
  s_add_u32 s50, s50, s52
  v_add_u32 v60, s51, v9
  v_lshrrev_b32 v62, 3, v60
  v_lshl_add_u32 v124, v62, 10, s52
  v_and_b32 v62, 1, v60
  v_lshl_add_u32 v124, v62, 8, v124
  v_and_b32 v62, 4, v60
  v_lshl_add_u32 v124, v62, 7, v124
  v_and_b32 v62, 2, v60
  v_lshl_add_u32 v124, v62, 2, v124
  v_add_u32 v64, v124, v63
  v_add_u32 v65, s50, v63
  ds_read_b64 v[80:81], v64
  s_mov_b64 exec, 0xffff
  ds_read_b64 v[82:83], v65
  s_mov_b64 exec, -1
  v_add_u32 v128, v124, v66
  v_add_u32 v129, s50, v66
  ds_read_b64 v[84:85], v128
  ds_read_b64 v[86:87], v129
  v_add_u32 v130, v124, v67
  v_add_u32 v131, s50, v67
  ds_read_b64 v[88:89], v130
  ds_read_b64 v[90:91], v131
  v_and_b32 v60, 3, v1
  v_add_u32 v60, s51, v60
  v_lshrrev_b32 v62, 3, v60
  v_lshl_add_u32 v125, v62, 10, s52
  v_and_b32 v62, 1, v60
  v_lshl_add_u32 v125, v62, 8, v125
  v_and_b32 v62, 4, v60
  v_lshl_add_u32 v125, v62, 7, v125
  v_and_b32 v62, 2, v60
  v_lshl_add_u32 v125, v62, 2, v125
  v_add_u32 v128, v125, v68
  v_add_u32 v129, s50, v68
  ds_read_b64_tr_b16 v[92:93], v128
  ds_read_b64_tr_b16 v[96:97], v129
  v_add_u32 v130, v125, v69
  v_add_u32 v131, s50, v69
  ds_read_b64_tr_b16 v[94:95], v130
  ds_read_b64_tr_b16 v[98:99], v131
  s_waitcnt lgkmcnt(4)
  v_mfma_f32_16x16x32_bf16 v[100:103], v[84:87], v[80:83], v[72:75]
  v_mfma_f32_16x16x32_bf16 v[104:107], v[88:91], v[80:83], v[76:79]
  s_nop 6
  v_max3_f32 v126, v100, v101, v102
  v_max3_f32 v127, v104, v105, v106
  v_max3_f32 v126, v126, v103, v107
  v_max_f32 v126, v126, v127
  v_mov_b32 v127, v126
  s_nop 1
  v_permlane32_swap_b32 v126, v127
  v_max_f32 v126, v126, v127
  v_mov_b32 v127, v126
  s_nop 1
  v_permlane16_swap_b32 v126, v127
  v_max_f32 v126, v126, v127
  v_mul_f32 v126, s53, v126
  v_fma_f32 v100, v100, s53, -v126
  v_fma_f32 v101, v101, s53, -v126
  v_fma_f32 v102, v102, s53, -v126
  v_fma_f32 v103, v103, s53, -v126
  v_fma_f32 v104, v104, s53, -v126
  v_fma_f32 v105, v105, s53, -v126
  v_fma_f32 v106, v106, s53, -v126
  v_fma_f32 v107, v107, s53, -v126
  v_exp_f32 v100, v100
  v_exp_f32 v101, v101
  v_exp_f32 v102, v102
  v_exp_f32 v103, v103
  v_exp_f32 v104, v104
  v_exp_f32 v105, v105
  v_exp_f32 v106, v106
  v_exp_f32 v107, v107
  v_cvt_pk_bf16_f32 v108, v100, v101
  v_cvt_pk_bf16_f32 v109, v102, v103
  v_cvt_pk_bf16_f32 v110, v104, v105
  v_cvt_pk_bf16_f32 v111, v106, v107
  s_waitcnt lgkmcnt(0)
  s_nop 0
  v_mfma_f32_16x16x32_bf16 v[120:123], v[44:47], v[108:111], 0
  v_mfma_f32_16x16x32_bf16 v[112:115], v[92:95], v[108:111], 0
  v_mfma_f32_16x16x32_bf16 v[116:119], v[96:99], v[108:111], 0
  s_nop 5
  v_rcp_f32 v126, v120
  s_nop 0
  v_mul_f32 v112, v112, v126
  v_mul_f32 v113, v113, v126
  v_mul_f32 v114, v114, v126
  v_mul_f32 v115, v115, v126
  v_cvt_pk_bf16_f32 v112, v112, v113
  v_cvt_pk_bf16_f32 v113, v114, v115
  v_mul_f32 v116, v116, v126
  v_mul_f32 v117, v117, v126
  v_mul_f32 v118, v118, v126
  v_mul_f32 v119, v119, v126
  v_cvt_pk_bf16_f32 v116, v116, v117
  v_cvt_pk_bf16_f32 v117, v118, v119
  ds_write_b64 v64, v[112:113]
  s_mov_b64 exec, 0xffff
  ds_write_b64 v65, v[116:117]
  s_mov_b64 exec, -1
  s_add_u32 s48, s48, 1
  s_cmp_lt_u32 s48, 4
  s_cbranch_scc1 CAT_l
  s_add_u32 s58, s58, 4096
  s_waitcnt lgkmcnt(0)
  s_mul_i32 s35, s44, 9216
  v_lshl_add_u32 v48, v1, 4, s35
  v_xor_b32 v49, 0x400, v48
  v_lshrrev_b32 v10, 2, v1
  v_and_b32 v10, 7, v10
  s_lshl_b32 s35, s45, 2
  v_xor_b32 v11, s35, v10
  v_lshlrev_b32 v10, 8, v10
  v_lshl_add_u32 v10, v11, 5, v10
  v_lshrrev_b32 v11, 5, v1
  v_mul_u32_u24 v11, 5120, v11
  v_add_u32 v10, v10, v11
  v_and_b32 v11, 3, v1
  v_lshl_add_u32 v10, v11, 3, v10
  s_mul_i32 s35, s44, 10240
  v_add_u32 v50, s35, v10
  s_sub_u32 s35, 10240, s35
  v_add_u32 v53, s35, v10
  s_mov_b32 s52, 55296
  s_lshl_b32 s50, s34, 1
  s_add_u32 s50, s50, s45
  s_cmp_ge_u32 s50, 27
  s_cselect_b32 s50, 0x80000, s50
  s_lshl_b32 s50, s50, 11
  s_mov_b32 s47, 40960
  s_lshl_b32 s35, s33, 3
  s_lshl_b32 s36, s44, 2
  s_add_u32 s35, s35, s36
  s_mul_i32 s53, s52, s35
  v_mov_b64 v[140:141], 0
  v_mov_b64 v[142:143], 0
  v_mov_b64 v[144:145], 0
  v_mov_b64 v[146:147], 0
  v_mov_b64 v[148:149], 0
  v_mov_b64 v[150:151], 0
  v_mov_b64 v[152:153], 0
  v_mov_b64 v[154:155], 0
  v_mov_b64 v[160:161], 0
  v_mov_b64 v[162:163], 0
  v_mov_b64 v[164:165], 0
  v_mov_b64 v[166:167], 0
  v_mov_b64 v[168:169], 0
  v_mov_b64 v[170:171], 0
  v_mov_b64 v[172:173], 0
  v_mov_b64 v[174:175], 0
  v_mov_b64 v[180:181], 0
  v_mov_b64 v[182:183], 0
  v_mov_b64 v[184:185], 0
  v_mov_b64 v[186:187], 0
  v_mov_b64 v[188:189], 0
  v_mov_b64 v[190:191], 0
  v_mov_b64 v[192:193], 0
  v_mov_b64 v[194:195], 0
  v_mov_b64 v[200:201], 0
  v_mov_b64 v[202:203], 0
  v_mov_b64 v[204:205], 0
  v_mov_b64 v[206:207], 0
  v_mov_b64 v[208:209], 0
  v_mov_b64 v[210:211], 0
  v_mov_b64 v[212:213], 0
  v_mov_b64 v[214:215], 0
  v_mov_b64 v[220:221], 0
  v_mov_b64 v[222:223], 0
  v_mov_b64 v[224:225], 0
  v_mov_b64 v[226:227], 0
  v_mov_b64 v[228:229], 0
  v_mov_b64 v[230:231], 0
  v_mov_b64 v[232:233], 0
  v_mov_b64 v[234:235], 0
  s_add_u32 s40, s24, 25165824
  s_addc_u32 s41, s25, 0
  s_mov_b32 s42, 7077888
  s_mov_b32 s43, 0x20000
  v_add_u32 v56, s46, v48
  v_add_u32 v58, s47, v50
  v_xor_b32 v59, 32, v58
  v_xor_b32 v60, 64, v58
  v_xor_b32 v61, 96, v58
  v_add_u32 v57, s46, v49
  v_add_u32 v62, s47, v53
  v_xor_b32 v63, 32, v62
  v_xor_b32 v64, 64, v62
  v_xor_b32 v65, 96, v62
  s_mov_b32 s48, 0
  s_barrier
  ds_read_b128 v[68:71], v56 offset:0
  ds_read_b64_tr_b16 v[100:101], v58 offset:0
  ds_read_b64_tr_b16 v[102:103], v58 offset:2048
  ds_read_b128 v[72:75], v56 offset:2048
  ds_read_b128 v[76:79], v56 offset:4096
  ds_read_b128 v[80:83], v56 offset:6144
  ds_read_b64_tr_b16 v[104:105], v59 offset:0
  ds_read_b64_tr_b16 v[106:107], v59 offset:2048
  ds_read_b64_tr_b16 v[108:109], v60 offset:0
  ds_read_b64_tr_b16 v[110:111], v60 offset:2048
  ds_read_b64_tr_b16 v[112:113], v61 offset:0
  ds_read_b64_tr_b16 v[114:115], v61 offset:2048
  s_branch C3_l
C3_cs:
  s_mul_i32 s35, s32, 320
  s_add_u32 s35, s35, 153600
  v_lshlrev_b32 v10, 4, v9
  v_add_u32 v11, s35, v10
  s_mov_b32 exec_lo, 0x00010001
  s_mov_b32 exec_hi, 0x00010001
  ds_write_b128 v11, v[220:223] offset:0
  ds_write_b128 v11, v[224:227] offset:64
  ds_write_b128 v11, v[228:231] offset:128
  ds_write_b128 v11, v[232:235] offset:192
  s_mov_b64 exec, -1
  s_xor_b32 s35, s32, 1
  s_mul_i32 s35, s35, 320
  s_add_u32 s35, s35, 153600
  v_add_u32 v11, s35, v10
  s_lshl_b32 s35, s44, 9
  s_add_u32 s35, s35, 151552
  v_lshl_add_u32 v10, v8, 3, s35
  s_branch C3_b
C3_l:
  s_add_u32 s46, s46, 16384
  s_cmp_eq_u32 s46, 151552
  s_cselect_b32 s46, 102400, s46
  s_add_u32 s47, s47, 20480
  s_cmp_eq_u32 s47, 102400
  s_cselect_b32 s47, 0, s47
  s_waitcnt lgkmcnt(0)
  v_mfma_f32_16x16x32_bf16 v[140:143], v[100:103], v[68:71], v[140:143]
  ds_read_b128 v[84:87], v57 offset:0
  v_mfma_f32_16x16x32_bf16 v[160:163], v[100:103], v[72:75], v[160:163]
  ds_read_b64_tr_b16 v[120:121], v62 offset:0
  v_mfma_f32_16x16x32_bf16 v[180:183], v[100:103], v[76:79], v[180:183]
  ds_read_b64_tr_b16 v[122:123], v62 offset:2048
  v_mfma_f32_16x16x32_bf16 v[200:203], v[100:103], v[80:83], v[200:203]
  ds_read_b128 v[88:91], v57 offset:2048
  v_mfma_f32_16x16x32_bf16 v[220:223], v[100:103], v[44:47], v[220:223]
  ds_read_b128 v[92:95], v57 offset:4096
  v_mfma_f32_16x16x32_bf16 v[144:147], v[104:107], v[68:71], v[144:147]
  ds_read_b128 v[96:99], v57 offset:6144
  v_mfma_f32_16x16x32_bf16 v[164:167], v[104:107], v[72:75], v[164:167]
  ds_read_b64_tr_b16 v[124:125], v63 offset:0
  v_mfma_f32_16x16x32_bf16 v[184:187], v[104:107], v[76:79], v[184:187]
  ds_read_b64_tr_b16 v[126:127], v63 offset:2048
  v_mfma_f32_16x16x32_bf16 v[204:207], v[104:107], v[80:83], v[204:207]
  ds_read_b64_tr_b16 v[128:129], v64 offset:0
  v_mfma_f32_16x16x32_bf16 v[224:227], v[104:107], v[44:47], v[224:227]
  ds_read_b64_tr_b16 v[130:131], v64 offset:2048
  v_mfma_f32_16x16x32_bf16 v[148:151], v[108:111], v[68:71], v[148:151]
  ds_read_b64_tr_b16 v[132:133], v65 offset:0
  v_mfma_f32_16x16x32_bf16 v[168:171], v[108:111], v[72:75], v[168:171]
  ds_read_b64_tr_b16 v[134:135], v65 offset:2048
  v_mfma_f32_16x16x32_bf16 v[188:191], v[108:111], v[76:79], v[188:191]
  v_add_u32 v56, s46, v48
  v_mfma_f32_16x16x32_bf16 v[208:211], v[108:111], v[80:83], v[208:211]
  v_add_u32 v58, s47, v50
  v_mfma_f32_16x16x32_bf16 v[228:231], v[108:111], v[44:47], v[228:231]
  v_xor_b32 v59, 32, v58
  v_mfma_f32_16x16x32_bf16 v[152:155], v[112:115], v[68:71], v[152:155]
  v_xor_b32 v60, 64, v58
  v_mfma_f32_16x16x32_bf16 v[172:175], v[112:115], v[72:75], v[172:175]
  v_xor_b32 v61, 96, v58
  v_mfma_f32_16x16x32_bf16 v[192:195], v[112:115], v[76:79], v[192:195]
  v_mfma_f32_16x16x32_bf16 v[212:215], v[112:115], v[80:83], v[212:215]
  v_mfma_f32_16x16x32_bf16 v[232:235], v[112:115], v[44:47], v[232:235]
  s_cmp_eq_u32 s48, 9
  s_cbranch_scc1 C3_cs
C3_b:
  s_waitcnt lgkmcnt(0)
  s_barrier
  v_mfma_f32_16x16x32_bf16 v[140:143], v[120:123], v[84:87], v[140:143]
  ds_read_b128 v[68:71], v56 offset:0
  v_mfma_f32_16x16x32_bf16 v[160:163], v[120:123], v[88:91], v[160:163]
  ds_read_b64_tr_b16 v[100:101], v58 offset:0
  v_mfma_f32_16x16x32_bf16 v[180:183], v[120:123], v[92:95], v[180:183]
  ds_read_b64_tr_b16 v[102:103], v58 offset:2048
  v_mfma_f32_16x16x32_bf16 v[200:203], v[120:123], v[96:99], v[200:203]
  ds_read_b128 v[72:75], v56 offset:2048
  v_mfma_f32_16x16x32_bf16 v[144:147], v[124:127], v[84:87], v[144:147]
  ds_read_b128 v[76:79], v56 offset:4096
  v_mfma_f32_16x16x32_bf16 v[164:167], v[124:127], v[88:91], v[164:167]
  ds_read_b128 v[80:83], v56 offset:6144
  v_mfma_f32_16x16x32_bf16 v[184:187], v[124:127], v[92:95], v[184:187]
  ds_read_b64_tr_b16 v[104:105], v59 offset:0
  v_mfma_f32_16x16x32_bf16 v[204:207], v[124:127], v[96:99], v[204:207]
  ds_read_b64_tr_b16 v[106:107], v59 offset:2048
  v_mfma_f32_16x16x32_bf16 v[148:151], v[128:131], v[84:87], v[148:151]
  ds_read_b64_tr_b16 v[108:109], v60 offset:0
  v_mfma_f32_16x16x32_bf16 v[168:171], v[128:131], v[88:91], v[168:171]
  ds_read_b64_tr_b16 v[110:111], v60 offset:2048
  v_mfma_f32_16x16x32_bf16 v[188:191], v[128:131], v[92:95], v[188:191]
  ds_read_b64_tr_b16 v[112:113], v61 offset:0
  v_mfma_f32_16x16x32_bf16 v[208:211], v[128:131], v[96:99], v[208:211]
  ds_read_b64_tr_b16 v[114:115], v61 offset:2048
  v_mfma_f32_16x16x32_bf16 v[152:155], v[132:135], v[84:87], v[152:155]
  v_add_u32 v57, s46, v49
  v_mfma_f32_16x16x32_bf16 v[172:175], v[132:135], v[88:91], v[172:175]
  v_add_u32 v62, s47, v53
  v_mfma_f32_16x16x32_bf16 v[192:195], v[132:135], v[92:95], v[192:195]
  v_xor_b32 v63, 32, v62
  v_xor_b32 v64, 64, v62
  v_xor_b32 v65, 96, v62
  v_mfma_f32_16x16x32_bf16 v[212:215], v[132:135], v[96:99], v[212:215]
  s_add_u32 s48, s48, 1
  s_cmp_lt_u32 s48, 10
  s_cbranch_scc1 C3_l
  ds_read_b128 v[100:103], v11 offset:0
  ds_read_b128 v[104:107], v11 offset:64
  ds_read_b128 v[108:111], v11 offset:128
  ds_read_b128 v[112:115], v11 offset:192
  ds_read_b64 v[68:69], v10 offset:0
  ds_read_b64 v[70:71], v10 offset:128
  ds_read_b64 v[72:73], v10 offset:256
  ds_read_b64 v[74:75], v10 offset:384
  v_lshl_add_u32 v58, v1, 4, s53
  v_add_u32 v59, s52, v58
  v_add_u32 v60, s52, v59
  v_add_u32 v61, s52, v60
  s_waitcnt lgkmcnt(0)
  v_pk_add_f32 v[220:221], v[220:221], v[100:101]
  v_pk_add_f32 v[222:223], v[222:223], v[102:103]
  v_pk_add_f32 v[224:225], v[224:225], v[104:105]
  v_pk_add_f32 v[226:227], v[226:227], v[106:107]
  v_pk_add_f32 v[228:229], v[228:229], v[108:109]
  v_pk_add_f32 v[230:231], v[230:231], v[110:111]
  v_pk_add_f32 v[232:233], v[232:233], v[112:113]
  v_pk_add_f32 v[234:235], v[234:235], v[114:115]
  v_pk_fma_f32 v[140:141], v[220:221], v[68:69], v[140:141] op_sel_hi:[1,0,1] neg_lo:[0,1,0] neg_hi:[0,1,0]
  v_pk_fma_f32 v[142:143], v[222:223], v[68:69], v[142:143] op_sel_hi:[1,0,1] neg_lo:[0,1,0] neg_hi:[0,1,0]
  v_pk_fma_f32 v[144:145], v[224:225], v[68:69], v[144:145] op_sel_hi:[1,0,1] neg_lo:[0,1,0] neg_hi:[0,1,0]
  v_pk_fma_f32 v[146:147], v[226:227], v[68:69], v[146:147] op_sel_hi:[1,0,1] neg_lo:[0,1,0] neg_hi:[0,1,0]
  v_pk_fma_f32 v[148:149], v[228:229], v[68:69], v[148:149] op_sel_hi:[1,0,1] neg_lo:[0,1,0] neg_hi:[0,1,0]
  v_pk_fma_f32 v[150:151], v[230:231], v[68:69], v[150:151] op_sel_hi:[1,0,1] neg_lo:[0,1,0] neg_hi:[0,1,0]
  v_pk_fma_f32 v[152:153], v[232:233], v[68:69], v[152:153] op_sel_hi:[1,0,1] neg_lo:[0,1,0] neg_hi:[0,1,0]
  v_pk_fma_f32 v[154:155], v[234:235], v[68:69], v[154:155] op_sel_hi:[1,0,1] neg_lo:[0,1,0] neg_hi:[0,1,0]
  v_mul_f32 v2, v69, v69
  v_mul_f32 v3, s61, v69
  v_mul_f32 v2, v2, v69
  v_rcp_f32 v69, v69
  v_mul_f32 v2, s60, v2
  v_pk_mul_f32 v[120:121], v[140:141], v[140:141]
  v_pk_mul_f32 v[122:123], v[142:143], v[142:143]
  v_pk_mul_f32 v[124:125], v[144:145], v[144:145]
  v_pk_mul_f32 v[126:127], v[146:147], v[146:147]
  v_pk_mul_f32 v[128:129], v[148:149], v[148:149]
  v_pk_mul_f32 v[130:131], v[150:151], v[150:151]
  v_pk_mul_f32 v[132:133], v[152:153], v[152:153]
  v_pk_mul_f32 v[134:135], v[154:155], v[154:155]
  v_pk_fma_f32 v[120:121], v[120:121], v[2:3], v[2:3] op_sel:[0,0,1] op_sel_hi:[1,0,1]
  v_pk_fma_f32 v[122:123], v[122:123], v[2:3], v[2:3] op_sel:[0,0,1] op_sel_hi:[1,0,1]
  v_pk_fma_f32 v[124:125], v[124:125], v[2:3], v[2:3] op_sel:[0,0,1] op_sel_hi:[1,0,1]
  v_pk_fma_f32 v[126:127], v[126:127], v[2:3], v[2:3] op_sel:[0,0,1] op_sel_hi:[1,0,1]
  v_pk_fma_f32 v[128:129], v[128:129], v[2:3], v[2:3] op_sel:[0,0,1] op_sel_hi:[1,0,1]
  v_pk_fma_f32 v[130:131], v[130:131], v[2:3], v[2:3] op_sel:[0,0,1] op_sel_hi:[1,0,1]
  v_pk_fma_f32 v[132:133], v[132:133], v[2:3], v[2:3] op_sel:[0,0,1] op_sel_hi:[1,0,1]
  v_pk_fma_f32 v[134:135], v[134:135], v[2:3], v[2:3] op_sel:[0,0,1] op_sel_hi:[1,0,1]
  v_pk_mul_f32 v[120:121], v[120:121], v[140:141]
  v_pk_mul_f32 v[122:123], v[122:123], v[142:143]
  v_pk_mul_f32 v[124:125], v[124:125], v[144:145]
  v_pk_mul_f32 v[126:127], v[126:127], v[146:147]
  v_pk_mul_f32 v[128:129], v[128:129], v[148:149]
  v_pk_mul_f32 v[130:131], v[130:131], v[150:151]
  v_pk_mul_f32 v[132:133], v[132:133], v[152:153]
  v_pk_mul_f32 v[134:135], v[134:135], v[154:155]
  v_exp_f32 v120, v120
  v_exp_f32 v121, v121
  v_exp_f32 v122, v122
  v_exp_f32 v123, v123
  v_exp_f32 v124, v124
  v_exp_f32 v125, v125
  v_exp_f32 v126, v126
  v_exp_f32 v127, v127
  v_exp_f32 v128, v128
  v_exp_f32 v129, v129
  v_exp_f32 v130, v130
  v_exp_f32 v131, v131
  v_exp_f32 v132, v132
  v_exp_f32 v133, v133
  v_exp_f32 v134, v134
  v_exp_f32 v135, v135
  v_pk_fma_f32 v[120:121], v[120:121], v[68:69], v[68:69] op_sel:[0,1,1] op_sel_hi:[1,1,1]
  v_pk_fma_f32 v[122:123], v[122:123], v[68:69], v[68:69] op_sel:[0,1,1] op_sel_hi:[1,1,1]
  v_pk_fma_f32 v[124:125], v[124:125], v[68:69], v[68:69] op_sel:[0,1,1] op_sel_hi:[1,1,1]
  v_pk_fma_f32 v[126:127], v[126:127], v[68:69], v[68:69] op_sel:[0,1,1] op_sel_hi:[1,1,1]
  v_pk_fma_f32 v[128:129], v[128:129], v[68:69], v[68:69] op_sel:[0,1,1] op_sel_hi:[1,1,1]
  v_pk_fma_f32 v[130:131], v[130:131], v[68:69], v[68:69] op_sel:[0,1,1] op_sel_hi:[1,1,1]
  v_pk_fma_f32 v[132:133], v[132:133], v[68:69], v[68:69] op_sel:[0,1,1] op_sel_hi:[1,1,1]
  v_pk_fma_f32 v[134:135], v[134:135], v[68:69], v[68:69] op_sel:[0,1,1] op_sel_hi:[1,1,1]
  v_rcp_f32 v120, v120
  v_rcp_f32 v121, v121
  v_rcp_f32 v122, v122
  v_rcp_f32 v123, v123
  v_rcp_f32 v124, v124
  v_rcp_f32 v125, v125
  v_rcp_f32 v126, v126
  v_rcp_f32 v127, v127
  v_rcp_f32 v128, v128
  v_rcp_f32 v129, v129
  v_rcp_f32 v130, v130
  v_rcp_f32 v131, v131
  v_rcp_f32 v132, v132
  v_rcp_f32 v133, v133
  v_rcp_f32 v134, v134
  v_rcp_f32 v135, v135
  v_pk_mul_f32 v[140:141], v[140:141], v[120:121]
  v_pk_mul_f32 v[142:143], v[142:143], v[122:123]
  v_pk_mul_f32 v[144:145], v[144:145], v[124:125]
  v_pk_mul_f32 v[146:147], v[146:147], v[126:127]
  v_pk_mul_f32 v[148:149], v[148:149], v[128:129]
  v_pk_mul_f32 v[150:151], v[150:151], v[130:131]
  v_pk_mul_f32 v[152:153], v[152:153], v[132:133]
  v_pk_mul_f32 v[154:155], v[154:155], v[134:135]
  v_cvt_pk_bf16_f32 v84, v140, v141
  v_cvt_pk_bf16_f32 v85, v142, v143
  v_cvt_pk_bf16_f32 v86, v144, v145
  v_cvt_pk_bf16_f32 v87, v146, v147
  v_cvt_pk_bf16_f32 v88, v148, v149
  v_cvt_pk_bf16_f32 v89, v150, v151
  v_cvt_pk_bf16_f32 v90, v152, v153
  v_cvt_pk_bf16_f32 v91, v154, v155
  v_permlane32_swap_b32 v84, v86
  v_permlane32_swap_b32 v85, v87
  v_permlane32_swap_b32 v88, v90
  v_permlane32_swap_b32 v89, v91
  buffer_store_dwordx4 v[84:87], v58, s[40:43], s50 offen sc1
  buffer_store_dwordx4 v[88:91], v58, s[40:43], s50 offen offset:1024 sc1
  v_pk_fma_f32 v[160:161], v[220:221], v[70:71], v[160:161] op_sel_hi:[1,0,1] neg_lo:[0,1,0] neg_hi:[0,1,0]
  v_pk_fma_f32 v[162:163], v[222:223], v[70:71], v[162:163] op_sel_hi:[1,0,1] neg_lo:[0,1,0] neg_hi:[0,1,0]
  v_pk_fma_f32 v[164:165], v[224:225], v[70:71], v[164:165] op_sel_hi:[1,0,1] neg_lo:[0,1,0] neg_hi:[0,1,0]
  v_pk_fma_f32 v[166:167], v[226:227], v[70:71], v[166:167] op_sel_hi:[1,0,1] neg_lo:[0,1,0] neg_hi:[0,1,0]
  v_pk_fma_f32 v[168:169], v[228:229], v[70:71], v[168:169] op_sel_hi:[1,0,1] neg_lo:[0,1,0] neg_hi:[0,1,0]
  v_pk_fma_f32 v[170:171], v[230:231], v[70:71], v[170:171] op_sel_hi:[1,0,1] neg_lo:[0,1,0] neg_hi:[0,1,0]
  v_pk_fma_f32 v[172:173], v[232:233], v[70:71], v[172:173] op_sel_hi:[1,0,1] neg_lo:[0,1,0] neg_hi:[0,1,0]
  v_pk_fma_f32 v[174:175], v[234:235], v[70:71], v[174:175] op_sel_hi:[1,0,1] neg_lo:[0,1,0] neg_hi:[0,1,0]
  v_mul_f32 v2, v71, v71
  v_mul_f32 v3, s61, v71
  v_mul_f32 v2, v2, v71
  v_rcp_f32 v71, v71
  v_mul_f32 v2, s60, v2
  v_pk_mul_f32 v[120:121], v[160:161], v[160:161]
  v_pk_mul_f32 v[122:123], v[162:163], v[162:163]
  v_pk_mul_f32 v[124:125], v[164:165], v[164:165]
  v_pk_mul_f32 v[126:127], v[166:167], v[166:167]
  v_pk_mul_f32 v[128:129], v[168:169], v[168:169]
  v_pk_mul_f32 v[130:131], v[170:171], v[170:171]
  v_pk_mul_f32 v[132:133], v[172:173], v[172:173]
  v_pk_mul_f32 v[134:135], v[174:175], v[174:175]
  v_pk_fma_f32 v[120:121], v[120:121], v[2:3], v[2:3] op_sel:[0,0,1] op_sel_hi:[1,0,1]
  v_pk_fma_f32 v[122:123], v[122:123], v[2:3], v[2:3] op_sel:[0,0,1] op_sel_hi:[1,0,1]
  v_pk_fma_f32 v[124:125], v[124:125], v[2:3], v[2:3] op_sel:[0,0,1] op_sel_hi:[1,0,1]
  v_pk_fma_f32 v[126:127], v[126:127], v[2:3], v[2:3] op_sel:[0,0,1] op_sel_hi:[1,0,1]
  v_pk_fma_f32 v[128:129], v[128:129], v[2:3], v[2:3] op_sel:[0,0,1] op_sel_hi:[1,0,1]
  v_pk_fma_f32 v[130:131], v[130:131], v[2:3], v[2:3] op_sel:[0,0,1] op_sel_hi:[1,0,1]
  v_pk_fma_f32 v[132:133], v[132:133], v[2:3], v[2:3] op_sel:[0,0,1] op_sel_hi:[1,0,1]
  v_pk_fma_f32 v[134:135], v[134:135], v[2:3], v[2:3] op_sel:[0,0,1] op_sel_hi:[1,0,1]
  v_pk_mul_f32 v[120:121], v[120:121], v[160:161]
  v_pk_mul_f32 v[122:123], v[122:123], v[162:163]
  v_pk_mul_f32 v[124:125], v[124:125], v[164:165]
  v_pk_mul_f32 v[126:127], v[126:127], v[166:167]
  v_pk_mul_f32 v[128:129], v[128:129], v[168:169]
  v_pk_mul_f32 v[130:131], v[130:131], v[170:171]
  v_pk_mul_f32 v[132:133], v[132:133], v[172:173]
  v_pk_mul_f32 v[134:135], v[134:135], v[174:175]
  v_exp_f32 v120, v120
  v_exp_f32 v121, v121
  v_exp_f32 v122, v122
  v_exp_f32 v123, v123
  v_exp_f32 v124, v124
  v_exp_f32 v125, v125
  v_exp_f32 v126, v126
  v_exp_f32 v127, v127
  v_exp_f32 v128, v128
  v_exp_f32 v129, v129
  v_exp_f32 v130, v130
  v_exp_f32 v131, v131
  v_exp_f32 v132, v132
  v_exp_f32 v133, v133
  v_exp_f32 v134, v134
  v_exp_f32 v135, v135
  v_pk_fma_f32 v[120:121], v[120:121], v[70:71], v[70:71] op_sel:[0,1,1] op_sel_hi:[1,1,1]
  v_pk_fma_f32 v[122:123], v[122:123], v[70:71], v[70:71] op_sel:[0,1,1] op_sel_hi:[1,1,1]
  v_pk_fma_f32 v[124:125], v[124:125], v[70:71], v[70:71] op_sel:[0,1,1] op_sel_hi:[1,1,1]
  v_pk_fma_f32 v[126:127], v[126:127], v[70:71], v[70:71] op_sel:[0,1,1] op_sel_hi:[1,1,1]
  v_pk_fma_f32 v[128:129], v[128:129], v[70:71], v[70:71] op_sel:[0,1,1] op_sel_hi:[1,1,1]
  v_pk_fma_f32 v[130:131], v[130:131], v[70:71], v[70:71] op_sel:[0,1,1] op_sel_hi:[1,1,1]
  v_pk_fma_f32 v[132:133], v[132:133], v[70:71], v[70:71] op_sel:[0,1,1] op_sel_hi:[1,1,1]
  v_pk_fma_f32 v[134:135], v[134:135], v[70:71], v[70:71] op_sel:[0,1,1] op_sel_hi:[1,1,1]
  v_rcp_f32 v120, v120
  v_rcp_f32 v121, v121
  v_rcp_f32 v122, v122
  v_rcp_f32 v123, v123
  v_rcp_f32 v124, v124
  v_rcp_f32 v125, v125
  v_rcp_f32 v126, v126
  v_rcp_f32 v127, v127
  v_rcp_f32 v128, v128
  v_rcp_f32 v129, v129
  v_rcp_f32 v130, v130
  v_rcp_f32 v131, v131
  v_rcp_f32 v132, v132
  v_rcp_f32 v133, v133
  v_rcp_f32 v134, v134
  v_rcp_f32 v135, v135
  v_pk_mul_f32 v[160:161], v[160:161], v[120:121]
  v_pk_mul_f32 v[162:163], v[162:163], v[122:123]
  v_pk_mul_f32 v[164:165], v[164:165], v[124:125]
  v_pk_mul_f32 v[166:167], v[166:167], v[126:127]
  v_pk_mul_f32 v[168:169], v[168:169], v[128:129]
  v_pk_mul_f32 v[170:171], v[170:171], v[130:131]
  v_pk_mul_f32 v[172:173], v[172:173], v[132:133]
  v_pk_mul_f32 v[174:175], v[174:175], v[134:135]
  v_cvt_pk_bf16_f32 v76, v160, v161
  v_cvt_pk_bf16_f32 v77, v162, v163
  v_cvt_pk_bf16_f32 v78, v164, v165
  v_cvt_pk_bf16_f32 v79, v166, v167
  v_cvt_pk_bf16_f32 v80, v168, v169
  v_cvt_pk_bf16_f32 v81, v170, v171
  v_cvt_pk_bf16_f32 v82, v172, v173
  v_cvt_pk_bf16_f32 v83, v174, v175
  v_permlane32_swap_b32 v76, v78
  v_permlane32_swap_b32 v77, v79
  v_permlane32_swap_b32 v80, v82
  v_permlane32_swap_b32 v81, v83
  buffer_store_dwordx4 v[76:79], v59, s[40:43], s50 offen sc1
  buffer_store_dwordx4 v[80:83], v59, s[40:43], s50 offen offset:1024 sc1
  v_pk_fma_f32 v[180:181], v[220:221], v[72:73], v[180:181] op_sel_hi:[1,0,1] neg_lo:[0,1,0] neg_hi:[0,1,0]
  v_pk_fma_f32 v[182:183], v[222:223], v[72:73], v[182:183] op_sel_hi:[1,0,1] neg_lo:[0,1,0] neg_hi:[0,1,0]
  v_pk_fma_f32 v[184:185], v[224:225], v[72:73], v[184:185] op_sel_hi:[1,0,1] neg_lo:[0,1,0] neg_hi:[0,1,0]
  v_pk_fma_f32 v[186:187], v[226:227], v[72:73], v[186:187] op_sel_hi:[1,0,1] neg_lo:[0,1,0] neg_hi:[0,1,0]
  v_pk_fma_f32 v[188:189], v[228:229], v[72:73], v[188:189] op_sel_hi:[1,0,1] neg_lo:[0,1,0] neg_hi:[0,1,0]
  v_pk_fma_f32 v[190:191], v[230:231], v[72:73], v[190:191] op_sel_hi:[1,0,1] neg_lo:[0,1,0] neg_hi:[0,1,0]
  v_pk_fma_f32 v[192:193], v[232:233], v[72:73], v[192:193] op_sel_hi:[1,0,1] neg_lo:[0,1,0] neg_hi:[0,1,0]
  v_pk_fma_f32 v[194:195], v[234:235], v[72:73], v[194:195] op_sel_hi:[1,0,1] neg_lo:[0,1,0] neg_hi:[0,1,0]
  v_mul_f32 v2, v73, v73
  v_mul_f32 v3, s61, v73
  v_mul_f32 v2, v2, v73
  v_rcp_f32 v73, v73
  v_mul_f32 v2, s60, v2
  v_pk_mul_f32 v[120:121], v[180:181], v[180:181]
  v_pk_mul_f32 v[122:123], v[182:183], v[182:183]
  v_pk_mul_f32 v[124:125], v[184:185], v[184:185]
  v_pk_mul_f32 v[126:127], v[186:187], v[186:187]
  v_pk_mul_f32 v[128:129], v[188:189], v[188:189]
  v_pk_mul_f32 v[130:131], v[190:191], v[190:191]
  v_pk_mul_f32 v[132:133], v[192:193], v[192:193]
  v_pk_mul_f32 v[134:135], v[194:195], v[194:195]
  v_pk_fma_f32 v[120:121], v[120:121], v[2:3], v[2:3] op_sel:[0,0,1] op_sel_hi:[1,0,1]
  v_pk_fma_f32 v[122:123], v[122:123], v[2:3], v[2:3] op_sel:[0,0,1] op_sel_hi:[1,0,1]
  v_pk_fma_f32 v[124:125], v[124:125], v[2:3], v[2:3] op_sel:[0,0,1] op_sel_hi:[1,0,1]
  v_pk_fma_f32 v[126:127], v[126:127], v[2:3], v[2:3] op_sel:[0,0,1] op_sel_hi:[1,0,1]
  v_pk_fma_f32 v[128:129], v[128:129], v[2:3], v[2:3] op_sel:[0,0,1] op_sel_hi:[1,0,1]
  v_pk_fma_f32 v[130:131], v[130:131], v[2:3], v[2:3] op_sel:[0,0,1] op_sel_hi:[1,0,1]
  v_pk_fma_f32 v[132:133], v[132:133], v[2:3], v[2:3] op_sel:[0,0,1] op_sel_hi:[1,0,1]
  v_pk_fma_f32 v[134:135], v[134:135], v[2:3], v[2:3] op_sel:[0,0,1] op_sel_hi:[1,0,1]
  v_pk_mul_f32 v[120:121], v[120:121], v[180:181]
  v_pk_mul_f32 v[122:123], v[122:123], v[182:183]
  v_pk_mul_f32 v[124:125], v[124:125], v[184:185]
  v_pk_mul_f32 v[126:127], v[126:127], v[186:187]
  v_pk_mul_f32 v[128:129], v[128:129], v[188:189]
  v_pk_mul_f32 v[130:131], v[130:131], v[190:191]
  v_pk_mul_f32 v[132:133], v[132:133], v[192:193]
  v_pk_mul_f32 v[134:135], v[134:135], v[194:195]
  v_exp_f32 v120, v120
  v_exp_f32 v121, v121
  v_exp_f32 v122, v122
  v_exp_f32 v123, v123
  v_exp_f32 v124, v124
  v_exp_f32 v125, v125
  v_exp_f32 v126, v126
  v_exp_f32 v127, v127
  v_exp_f32 v128, v128
  v_exp_f32 v129, v129
  v_exp_f32 v130, v130
  v_exp_f32 v131, v131
  v_exp_f32 v132, v132
  v_exp_f32 v133, v133
  v_exp_f32 v134, v134
  v_exp_f32 v135, v135
  v_pk_fma_f32 v[120:121], v[120:121], v[72:73], v[72:73] op_sel:[0,1,1] op_sel_hi:[1,1,1]
  v_pk_fma_f32 v[122:123], v[122:123], v[72:73], v[72:73] op_sel:[0,1,1] op_sel_hi:[1,1,1]
  v_pk_fma_f32 v[124:125], v[124:125], v[72:73], v[72:73] op_sel:[0,1,1] op_sel_hi:[1,1,1]
  v_pk_fma_f32 v[126:127], v[126:127], v[72:73], v[72:73] op_sel:[0,1,1] op_sel_hi:[1,1,1]
  v_pk_fma_f32 v[128:129], v[128:129], v[72:73], v[72:73] op_sel:[0,1,1] op_sel_hi:[1,1,1]
  v_pk_fma_f32 v[130:131], v[130:131], v[72:73], v[72:73] op_sel:[0,1,1] op_sel_hi:[1,1,1]
  v_pk_fma_f32 v[132:133], v[132:133], v[72:73], v[72:73] op_sel:[0,1,1] op_sel_hi:[1,1,1]
  v_pk_fma_f32 v[134:135], v[134:135], v[72:73], v[72:73] op_sel:[0,1,1] op_sel_hi:[1,1,1]
  v_rcp_f32 v120, v120
  v_rcp_f32 v121, v121
  v_rcp_f32 v122, v122
  v_rcp_f32 v123, v123
  v_rcp_f32 v124, v124
  v_rcp_f32 v125, v125
  v_rcp_f32 v126, v126
  v_rcp_f32 v127, v127
  v_rcp_f32 v128, v128
  v_rcp_f32 v129, v129
  v_rcp_f32 v130, v130
  v_rcp_f32 v131, v131
  v_rcp_f32 v132, v132
  v_rcp_f32 v133, v133
  v_rcp_f32 v134, v134
  v_rcp_f32 v135, v135
  v_pk_mul_f32 v[180:181], v[180:181], v[120:121]
  v_pk_mul_f32 v[182:183], v[182:183], v[122:123]
  v_pk_mul_f32 v[184:185], v[184:185], v[124:125]
  v_pk_mul_f32 v[186:187], v[186:187], v[126:127]
  v_pk_mul_f32 v[188:189], v[188:189], v[128:129]
  v_pk_mul_f32 v[190:191], v[190:191], v[130:131]
  v_pk_mul_f32 v[192:193], v[192:193], v[132:133]
  v_pk_mul_f32 v[194:195], v[194:195], v[134:135]
  v_cvt_pk_bf16_f32 v84, v180, v181
  v_cvt_pk_bf16_f32 v85, v182, v183
  v_cvt_pk_bf16_f32 v86, v184, v185
  v_cvt_pk_bf16_f32 v87, v186, v187
  v_cvt_pk_bf16_f32 v88, v188, v189
  v_cvt_pk_bf16_f32 v89, v190, v191
  v_cvt_pk_bf16_f32 v90, v192, v193
  v_cvt_pk_bf16_f32 v91, v194, v195
  v_permlane32_swap_b32 v84, v86
  v_permlane32_swap_b32 v85, v87
  v_permlane32_swap_b32 v88, v90
  v_permlane32_swap_b32 v89, v91
  buffer_store_dwordx4 v[84:87], v60, s[40:43], s50 offen sc1
  buffer_store_dwordx4 v[88:91], v60, s[40:43], s50 offen offset:1024 sc1
  v_pk_fma_f32 v[200:201], v[220:221], v[74:75], v[200:201] op_sel_hi:[1,0,1] neg_lo:[0,1,0] neg_hi:[0,1,0]
  v_pk_fma_f32 v[202:203], v[222:223], v[74:75], v[202:203] op_sel_hi:[1,0,1] neg_lo:[0,1,0] neg_hi:[0,1,0]
  v_pk_fma_f32 v[204:205], v[224:225], v[74:75], v[204:205] op_sel_hi:[1,0,1] neg_lo:[0,1,0] neg_hi:[0,1,0]
  v_pk_fma_f32 v[206:207], v[226:227], v[74:75], v[206:207] op_sel_hi:[1,0,1] neg_lo:[0,1,0] neg_hi:[0,1,0]
  v_pk_fma_f32 v[208:209], v[228:229], v[74:75], v[208:209] op_sel_hi:[1,0,1] neg_lo:[0,1,0] neg_hi:[0,1,0]
  v_pk_fma_f32 v[210:211], v[230:231], v[74:75], v[210:211] op_sel_hi:[1,0,1] neg_lo:[0,1,0] neg_hi:[0,1,0]
  v_pk_fma_f32 v[212:213], v[232:233], v[74:75], v[212:213] op_sel_hi:[1,0,1] neg_lo:[0,1,0] neg_hi:[0,1,0]
  v_pk_fma_f32 v[214:215], v[234:235], v[74:75], v[214:215] op_sel_hi:[1,0,1] neg_lo:[0,1,0] neg_hi:[0,1,0]
  v_mul_f32 v2, v75, v75
  v_mul_f32 v3, s61, v75
  v_mul_f32 v2, v2, v75
  v_rcp_f32 v75, v75
  v_mul_f32 v2, s60, v2
  v_pk_mul_f32 v[120:121], v[200:201], v[200:201]
  v_pk_mul_f32 v[122:123], v[202:203], v[202:203]
  v_pk_mul_f32 v[124:125], v[204:205], v[204:205]
  v_pk_mul_f32 v[126:127], v[206:207], v[206:207]
  v_pk_mul_f32 v[128:129], v[208:209], v[208:209]
  v_pk_mul_f32 v[130:131], v[210:211], v[210:211]
  v_pk_mul_f32 v[132:133], v[212:213], v[212:213]
  v_pk_mul_f32 v[134:135], v[214:215], v[214:215]
  v_pk_fma_f32 v[120:121], v[120:121], v[2:3], v[2:3] op_sel:[0,0,1] op_sel_hi:[1,0,1]
  v_pk_fma_f32 v[122:123], v[122:123], v[2:3], v[2:3] op_sel:[0,0,1] op_sel_hi:[1,0,1]
  v_pk_fma_f32 v[124:125], v[124:125], v[2:3], v[2:3] op_sel:[0,0,1] op_sel_hi:[1,0,1]
  v_pk_fma_f32 v[126:127], v[126:127], v[2:3], v[2:3] op_sel:[0,0,1] op_sel_hi:[1,0,1]
  v_pk_fma_f32 v[128:129], v[128:129], v[2:3], v[2:3] op_sel:[0,0,1] op_sel_hi:[1,0,1]
  v_pk_fma_f32 v[130:131], v[130:131], v[2:3], v[2:3] op_sel:[0,0,1] op_sel_hi:[1,0,1]
  v_pk_fma_f32 v[132:133], v[132:133], v[2:3], v[2:3] op_sel:[0,0,1] op_sel_hi:[1,0,1]
  v_pk_fma_f32 v[134:135], v[134:135], v[2:3], v[2:3] op_sel:[0,0,1] op_sel_hi:[1,0,1]
  v_pk_mul_f32 v[120:121], v[120:121], v[200:201]
  v_pk_mul_f32 v[122:123], v[122:123], v[202:203]
  v_pk_mul_f32 v[124:125], v[124:125], v[204:205]
  v_pk_mul_f32 v[126:127], v[126:127], v[206:207]
  v_pk_mul_f32 v[128:129], v[128:129], v[208:209]
  v_pk_mul_f32 v[130:131], v[130:131], v[210:211]
  v_pk_mul_f32 v[132:133], v[132:133], v[212:213]
  v_pk_mul_f32 v[134:135], v[134:135], v[214:215]
  v_exp_f32 v120, v120
  v_exp_f32 v121, v121
  v_exp_f32 v122, v122
  v_exp_f32 v123, v123
  v_exp_f32 v124, v124
  v_exp_f32 v125, v125
  v_exp_f32 v126, v126
  v_exp_f32 v127, v127
  v_exp_f32 v128, v128
  v_exp_f32 v129, v129
  v_exp_f32 v130, v130
  v_exp_f32 v131, v131
  v_exp_f32 v132, v132
  v_exp_f32 v133, v133
  v_exp_f32 v134, v134
  v_exp_f32 v135, v135
  v_pk_fma_f32 v[120:121], v[120:121], v[74:75], v[74:75] op_sel:[0,1,1] op_sel_hi:[1,1,1]
  v_pk_fma_f32 v[122:123], v[122:123], v[74:75], v[74:75] op_sel:[0,1,1] op_sel_hi:[1,1,1]
  v_pk_fma_f32 v[124:125], v[124:125], v[74:75], v[74:75] op_sel:[0,1,1] op_sel_hi:[1,1,1]
  v_pk_fma_f32 v[126:127], v[126:127], v[74:75], v[74:75] op_sel:[0,1,1] op_sel_hi:[1,1,1]
  v_pk_fma_f32 v[128:129], v[128:129], v[74:75], v[74:75] op_sel:[0,1,1] op_sel_hi:[1,1,1]
  v_pk_fma_f32 v[130:131], v[130:131], v[74:75], v[74:75] op_sel:[0,1,1] op_sel_hi:[1,1,1]
  v_pk_fma_f32 v[132:133], v[132:133], v[74:75], v[74:75] op_sel:[0,1,1] op_sel_hi:[1,1,1]
  v_pk_fma_f32 v[134:135], v[134:135], v[74:75], v[74:75] op_sel:[0,1,1] op_sel_hi:[1,1,1]
  v_rcp_f32 v120, v120
  v_rcp_f32 v121, v121
  v_rcp_f32 v122, v122
  v_rcp_f32 v123, v123
  v_rcp_f32 v124, v124
  v_rcp_f32 v125, v125
  v_rcp_f32 v126, v126
  v_rcp_f32 v127, v127
  v_rcp_f32 v128, v128
  v_rcp_f32 v129, v129
  v_rcp_f32 v130, v130
  v_rcp_f32 v131, v131
  v_rcp_f32 v132, v132
  v_rcp_f32 v133, v133
  v_rcp_f32 v134, v134
  v_rcp_f32 v135, v135
  v_pk_mul_f32 v[200:201], v[200:201], v[120:121]
  v_pk_mul_f32 v[202:203], v[202:203], v[122:123]
  v_pk_mul_f32 v[204:205], v[204:205], v[124:125]
  v_pk_mul_f32 v[206:207], v[206:207], v[126:127]
  v_pk_mul_f32 v[208:209], v[208:209], v[128:129]
  v_pk_mul_f32 v[210:211], v[210:211], v[130:131]
  v_pk_mul_f32 v[212:213], v[212:213], v[132:133]
  v_pk_mul_f32 v[214:215], v[214:215], v[134:135]
  v_cvt_pk_bf16_f32 v76, v200, v201
  v_cvt_pk_bf16_f32 v77, v202, v203
  v_cvt_pk_bf16_f32 v78, v204, v205
  v_cvt_pk_bf16_f32 v79, v206, v207
  v_cvt_pk_bf16_f32 v80, v208, v209
  v_cvt_pk_bf16_f32 v81, v210, v211
  v_cvt_pk_bf16_f32 v82, v212, v213
  v_cvt_pk_bf16_f32 v83, v214, v215
  v_permlane32_swap_b32 v76, v78
  v_permlane32_swap_b32 v77, v79
  v_permlane32_swap_b32 v80, v82
  v_permlane32_swap_b32 v81, v83
  buffer_store_dwordx4 v[76:79], v61, s[40:43], s50 offen sc1
  buffer_store_dwordx4 v[80:83], v61, s[40:43], s50 offen offset:1024 sc1
  v_mov_b64 v[116:117], 0
  v_mov_b64 v[118:119], 0
  v_mov_b64 v[120:121], 0
  v_mov_b64 v[122:123], 0
  v_mov_b64 v[124:125], 0
  v_mov_b64 v[126:127], 0
  v_mov_b64 v[128:129], 0
  v_mov_b64 v[130:131], 0
  v_mov_b64 v[132:133], 0
  v_mov_b64 v[134:135], 0
  s_mov_b32 s48, 5
  s_mov_b32 s37, 4
  s_branch CS_in
CS_sig:
  v_mov_b32 v2, 154888
  v_mov_b32 v3, 1
  s_waitcnt vmcnt(0)
  s_mov_b64 exec, 1
  buffer_store_dword v12, off, s[28:31], s58 sc1
  ds_add_u32 v2, v3
  s_mov_b64 exec, -1
  s_add_u32 s58, s58, 4096
  s_mov_b32 s37, -1
  s_branch CS_r
CA3:
  v_mov_b64 v[156:157], v[116:117]
  v_mov_b64 v[158:159], v[118:119]
  v_mov_b64 v[160:161], v[120:121]
  v_mov_b64 v[162:163], v[122:123]
  v_mov_b64 v[164:165], v[124:125]
  v_mov_b64 v[166:167], v[126:127]
  v_mov_b64 v[168:169], v[128:129]
  v_mov_b64 v[170:171], v[130:131]
  v_mov_b64 v[172:173], v[132:133]
  v_mov_b64 v[174:175], v[134:135]
  v_mov_b64 v[176:177], v[136:137]
  v_mov_b64 v[178:179], v[138:139]
  v_mov_b64 v[180:181], v[140:141]
  v_mov_b64 v[182:183], v[142:143]
  v_mov_b64 v[184:185], v[144:145]
  v_mov_b64 v[186:187], v[146:147]
  v_mov_b64 v[188:189], v[148:149]
  v_mov_b64 v[190:191], v[150:151]
  v_mov_b64 v[192:193], v[152:153]
  v_mov_b64 v[194:195], v[154:155]
  v_lshlrev_b32 v116, 16, v28
  v_and_b32 v117, 0xffff0000, v28
  v_lshlrev_b32 v118, 16, v29
  v_and_b32 v119, 0xffff0000, v29
  v_lshlrev_b32 v120, 16, v30
  v_and_b32 v121, 0xffff0000, v30
  v_lshlrev_b32 v122, 16, v31
  v_and_b32 v123, 0xffff0000, v31
  v_lshlrev_b32 v124, 16, v32
  v_and_b32 v125, 0xffff0000, v32
  v_lshlrev_b32 v126, 16, v33
  v_and_b32 v127, 0xffff0000, v33
  v_lshlrev_b32 v128, 16, v34
  v_and_b32 v129, 0xffff0000, v34
  v_lshlrev_b32 v130, 16, v35
  v_and_b32 v131, 0xffff0000, v35
  v_lshlrev_b32 v132, 16, v36
  v_and_b32 v133, 0xffff0000, v36
  v_lshlrev_b32 v134, 16, v37
  v_and_b32 v135, 0xffff0000, v37
  v_lshlrev_b32 v196, 16, v16
  v_and_b32 v197, 0xffff0000, v16
  v_lshlrev_b32 v198, 16, v17
  v_and_b32 v199, 0xffff0000, v17
  v_lshlrev_b32 v200, 16, v18
  v_and_b32 v201, 0xffff0000, v18
  v_lshlrev_b32 v202, 16, v19
  v_and_b32 v203, 0xffff0000, v19
  v_lshlrev_b32 v204, 16, v20
  v_and_b32 v205, 0xffff0000, v20
  v_lshlrev_b32 v206, 16, v21
  v_and_b32 v207, 0xffff0000, v21
  v_lshlrev_b32 v208, 16, v22
  v_and_b32 v209, 0xffff0000, v22
  v_lshlrev_b32 v210, 16, v23
  v_and_b32 v211, 0xffff0000, v23
  v_lshlrev_b32 v212, 16, v24
  v_and_b32 v213, 0xffff0000, v24
  v_lshlrev_b32 v214, 16, v25
  v_and_b32 v215, 0xffff0000, v25
  s_mov_b32 s40, s20
  s_mov_b32 s41, s21
  s_mov_b32 s42, 2621440
  s_mov_b32 s43, 0x20000
  s_mov_b32 s48, 14
  s_waitcnt lgkmcnt(0)
  s_branch CS_in
CS4:
  ds_write_b128 v10, v[176:179] offset:5120
  ds_write_b128 v10, v[180:183] offset:6144
  ds_write_b128 v10, v[184:187] offset:7168
  ds_write_b128 v10, v[188:191] offset:8192
  ds_write_b128 v10, v[192:195] offset:9216
  s_mov_b32 s35, 0xbfb8aa3b
  s_waitcnt lgkmcnt(0)
  s_barrier
  ds_read_b128 v[76:79], v11 offset:0
  ds_read_b128 v[80:83], v11 offset:1024
  ds_read_b128 v[84:87], v11 offset:2048
  ds_read_b128 v[88:91], v11 offset:3072
  ds_read_b128 v[92:95], v11 offset:4096
  ds_read_b128 v[96:99], v11 offset:5120
  ds_read_b128 v[100:103], v11 offset:6144
  ds_read_b128 v[104:107], v11 offset:7168
  ds_read_b128 v[108:111], v11 offset:8192
  ds_read_b128 v[112:115], v11 offset:9216
  s_waitcnt lgkmcnt(5)
  v_pk_add_f32 v[116:117], v[116:117], v[76:77]
  v_pk_add_f32 v[118:119], v[118:119], v[78:79]
  v_pk_add_f32 v[120:121], v[120:121], v[80:81]
  v_pk_add_f32 v[122:123], v[122:123], v[82:83]
  v_pk_add_f32 v[124:125], v[124:125], v[84:85]
  v_pk_add_f32 v[126:127], v[126:127], v[86:87]
  v_pk_add_f32 v[128:129], v[128:129], v[88:89]
  v_pk_add_f32 v[130:131], v[130:131], v[90:91]
  v_pk_add_f32 v[132:133], v[132:133], v[92:93]
  v_pk_add_f32 v[134:135], v[134:135], v[94:95]
  v_mul_f32 v76, s35, v116
  v_mul_f32 v77, s35, v117
  v_mul_f32 v78, s35, v118
  v_mul_f32 v79, s35, v119
  v_mul_f32 v80, s35, v120
  v_mul_f32 v81, s35, v121
  v_mul_f32 v82, s35, v122
  v_mul_f32 v83, s35, v123
  v_mul_f32 v84, s35, v124
  v_mul_f32 v85, s35, v125
  v_mul_f32 v86, s35, v126
  v_mul_f32 v87, s35, v127
  v_mul_f32 v88, s35, v128
  v_mul_f32 v89, s35, v129
  v_mul_f32 v90, s35, v130
  v_mul_f32 v91, s35, v131
  v_mul_f32 v92, s35, v132
  v_mul_f32 v93, s35, v133
  v_mul_f32 v94, s35, v134
  v_mul_f32 v95, s35, v135
  v_exp_f32 v76, v76
  v_exp_f32 v77, v77
  v_exp_f32 v78, v78
  v_exp_f32 v79, v79
  v_exp_f32 v80, v80
  v_exp_f32 v81, v81
  v_exp_f32 v82, v82
  v_exp_f32 v83, v83
  v_exp_f32 v84, v84
  v_exp_f32 v85, v85
  v_exp_f32 v86, v86
  v_exp_f32 v87, v87
  v_exp_f32 v88, v88
  v_exp_f32 v89, v89
  v_exp_f32 v90, v90
  v_exp_f32 v91, v91
  v_exp_f32 v92, v92
  v_exp_f32 v93, v93
  v_exp_f32 v94, v94
  v_exp_f32 v95, v95
  s_waitcnt lgkmcnt(0)
  v_pk_add_f32 v[156:157], v[156:157], v[96:97]
  v_pk_add_f32 v[158:159], v[158:159], v[98:99]
  v_pk_add_f32 v[160:161], v[160:161], v[100:101]
  v_pk_add_f32 v[162:163], v[162:163], v[102:103]
  v_pk_add_f32 v[164:165], v[164:165], v[104:105]
  v_pk_add_f32 v[166:167], v[166:167], v[106:107]
  v_pk_add_f32 v[168:169], v[168:169], v[108:109]
  v_pk_add_f32 v[170:171], v[170:171], v[110:111]
  v_pk_add_f32 v[172:173], v[172:173], v[112:113]
  v_pk_add_f32 v[174:175], v[174:175], v[114:115]
  v_pk_add_f32 v[76:77], v[76:77], 1.0 op_sel_hi:[1,0]
  v_pk_add_f32 v[78:79], v[78:79], 1.0 op_sel_hi:[1,0]
  v_pk_add_f32 v[80:81], v[80:81], 1.0 op_sel_hi:[1,0]
  v_pk_add_f32 v[82:83], v[82:83], 1.0 op_sel_hi:[1,0]
  v_pk_add_f32 v[84:85], v[84:85], 1.0 op_sel_hi:[1,0]
  v_pk_add_f32 v[86:87], v[86:87], 1.0 op_sel_hi:[1,0]
  v_pk_add_f32 v[88:89], v[88:89], 1.0 op_sel_hi:[1,0]
  v_pk_add_f32 v[90:91], v[90:91], 1.0 op_sel_hi:[1,0]
  v_pk_add_f32 v[92:93], v[92:93], 1.0 op_sel_hi:[1,0]
  v_pk_add_f32 v[94:95], v[94:95], 1.0 op_sel_hi:[1,0]
  v_rcp_f32 v76, v76
  v_rcp_f32 v77, v77
  v_rcp_f32 v78, v78
  v_rcp_f32 v79, v79
  v_rcp_f32 v80, v80
  v_rcp_f32 v81, v81
  v_rcp_f32 v82, v82
  v_rcp_f32 v83, v83
  v_rcp_f32 v84, v84
  v_rcp_f32 v85, v85
  v_rcp_f32 v86, v86
  v_rcp_f32 v87, v87
  v_rcp_f32 v88, v88
  v_rcp_f32 v89, v89
  v_rcp_f32 v90, v90
  v_rcp_f32 v91, v91
  v_rcp_f32 v92, v92
  v_rcp_f32 v93, v93
  v_rcp_f32 v94, v94
  v_rcp_f32 v95, v95
  v_pk_mul_f32 v[116:117], v[116:117], v[156:157]
  v_pk_mul_f32 v[118:119], v[118:119], v[158:159]
  v_pk_mul_f32 v[120:121], v[120:121], v[160:161]
  v_pk_mul_f32 v[122:123], v[122:123], v[162:163]
  v_pk_mul_f32 v[124:125], v[124:125], v[164:165]
  v_pk_mul_f32 v[126:127], v[126:127], v[166:167]
  v_pk_mul_f32 v[128:129], v[128:129], v[168:169]
  v_pk_mul_f32 v[130:131], v[130:131], v[170:171]
  v_pk_mul_f32 v[132:133], v[132:133], v[172:173]
  v_pk_mul_f32 v[134:135], v[134:135], v[174:175]
  v_pk_fma_f32 v[116:117], v[116:117], v[76:77], v[196:197]
  v_pk_fma_f32 v[118:119], v[118:119], v[78:79], v[198:199]
  v_pk_fma_f32 v[120:121], v[120:121], v[80:81], v[200:201]
  v_pk_fma_f32 v[122:123], v[122:123], v[82:83], v[202:203]
  v_pk_fma_f32 v[124:125], v[124:125], v[84:85], v[204:205]
  v_pk_fma_f32 v[126:127], v[126:127], v[86:87], v[206:207]
  v_pk_fma_f32 v[128:129], v[128:129], v[88:89], v[208:209]
  v_pk_fma_f32 v[130:131], v[130:131], v[90:91], v[210:211]
  v_pk_fma_f32 v[132:133], v[132:133], v[92:93], v[212:213]
  v_pk_fma_f32 v[134:135], v[134:135], v[94:95], v[214:215]
  v_cvt_pk_bf16_f32 v28, v116, v117
  v_cvt_pk_bf16_f32 v29, v118, v119
  v_cvt_pk_bf16_f32 v30, v120, v121
  v_cvt_pk_bf16_f32 v31, v122, v123
  v_cvt_pk_bf16_f32 v32, v124, v125
  v_cvt_pk_bf16_f32 v33, v126, v127
  v_cvt_pk_bf16_f32 v34, v128, v129
  v_cvt_pk_bf16_f32 v35, v130, v131
  v_cvt_pk_bf16_f32 v36, v132, v133
  v_cvt_pk_bf16_f32 v37, v134, v135
  v_and_b32 v10, 1, v9
  v_mul_u32_u24 v10, 24, v10
  v_add_u32 v10, v10, v42
  v_permlane16_swap_b32 v28, v30
  v_permlane16_swap_b32 v29, v31
  buffer_store_dwordx4 v[28:31], v10, s[40:43], s54 offen offset:0
  v_permlane16_swap_b32 v32, v34
  v_permlane16_swap_b32 v33, v35
  buffer_store_dwordx4 v[32:35], v10, s[40:43], s54 offen offset:64
  buffer_store_dwordx2 v[36:37], v42, s[40:43], s55 offen
L_end:
  s_endpgm
.section .rodata,"a"
.p2align 6
.amdhsa_kernel recurrent_scan__sliding_local_dilated__mixer_s_mlp__prompt_kernel
  .amdhsa_next_free_vgpr 240
  .amdhsa_next_free_sgpr 102
  .amdhsa_accum_offset 240
  .amdhsa_group_segment_fixed_size 0
  .amdhsa_kernarg_size 88
  .amdhsa_user_sgpr_count 2
  .amdhsa_user_sgpr_kernarg_segment_ptr 1
  .amdhsa_system_sgpr_workgroup_id_x 1
.end_amdhsa_kernel
```
